```python
import torch

def _softmax(x, axis=-1):
    return torch.softmax(x, dim=axis)

def _gelu(x):
    return torch.nn.functional.gelu(x, approximate='tanh')

def _silu(x):
    return torch.nn.functional.silu(x)

def _sigmoid(x):
    return torch.sigmoid(x)

def _layernorm(x, axis=-1, eps=1e-05):
    m = x.mean(dim=axis, keepdim=True)
    v = x.var(dim=axis, keepdim=True, unbiased=False)
    return (x - m) / torch.sqrt(v + eps)

def _scatter_add(tgt, idx, src, axis=0):
    return tgt.clone().index_add_(axis, idx, src)

def _segment_sum(src, seg, n):
    out = torch.zeros((n,) + src.shape[1:], dtype=src.dtype)
    return out.index_add_(0, seg, src)

def _pad(x, pw):
    flat = tuple((v for pair in reversed(pw) for v in pair))
    return torch.nn.functional.pad(x, flat)
kernel_name = 'adaLN_cond__spectral_gfnet__dense_activation_silu__prompt'

def setup_inputs():

    _w = lambda a: (lambda t: t.to(torch.bfloat16) if t.is_floating_point() else t)(torch.as_tensor(a))

    def _A_setup():
        B, S, D = (1, 2048, 512)
        Df = D // 2 + 1
        return {'x': _w((lambda *s: torch.randn(*s, dtype=torch.bfloat16) * 0.05)(B, S, D)), 'w_r': _w((lambda *s: torch.randn(*s, dtype=torch.bfloat16) * 1.6)(S, Df) * 0.02), 'w_i': _w((lambda *s: torch.randn(*s, dtype=torch.bfloat16) * 1.6)(S, Df) * 0.02)}
    _A_in = _A_setup()

    def _B_setup():
        B, S, D, F = (1, 2048, 512, 1792)
        return {'x': _w((lambda *s: torch.randn(*s, dtype=torch.bfloat16) * 0.05)(B, S, D)), 'w1': _w((lambda *s: torch.randn(*s, dtype=torch.bfloat16) * 0.8)(D, F) * D ** (-0.5)), 'w2': _w((lambda *s: torch.randn(*s, dtype=torch.bfloat16) * 0.2)(F, D) * F ** (-0.5))}
    _B_in = _B_setup()
    return {'A_x': _A_in['x'], 'A_w_r': _A_in['w_r'], 'A_w_i': _A_in['w_i'], 'B_x': _B_in['x'], 'B_w1': _B_in['w1'], 'B_w2': _B_in['w2'], 'c': _w((lambda *s: torch.randn(*s, dtype=torch.bfloat16) * 0.2)(1, 512) * 8.0), 'w_mod': _w((lambda *s: torch.randn(*s, dtype=torch.bfloat16) * 0.2)(512, 6 * 512) * 512 ** (-0.5) * 8.0)}

def reference(A_x, A_w_r, A_w_i, B_x, B_w1, B_w2, c, w_mod):

    def _A_ref(x, w_r, w_i):
        B, S, D = x.shape
        X = (lambda x, axes=(-2, -1): torch.fft.rfft2(x.float(), dim=axes))(x, axes=(-2, -1))
        W = w_r + 1j * w_i
        X = X * W
        y = (lambda x, s, axes=(-2, -1): torch.fft.irfft2(x, s=s, dim=axes).to(torch.bfloat16))(X, (S, D), axes=(-2, -1))
        return y

    def _B_ref(x, w1, w2):
        h = torch.einsum('bsd,df->bsf', x, w1)
        h = _silu(h)
        out = torch.einsum('bsf,fd->bsd', h, w2)
        return out
    x = A_x
    mod = (_silu(c) @ w_mod).reshape(c.shape[0], 6, 1, -1)
    sa, ca, ga, sb, cb, gb = (mod[:, 0].clone(), mod[:, 1].clone(), mod[:, 2].clone(), mod[:, 3].clone(), mod[:, 4].clone(), mod[:, 5].clone())
    h = _layernorm(x, axis=-1) * (1 + ca) + sa
    x = x + ga * _A_ref(h, A_w_r, A_w_i)
    h = _layernorm(x, axis=-1) * (1 + cb) + sb
    x = x + gb * _B_ref(h, B_w1, B_w2)
    return x
```

```asm
; @launch grid=(256,1,1) block=(512,1,1) lds=151616
.amdgcn_target "amdgcn-amd-amdhsa--gfx950"
.text
.globl adaLN_cond__spectral_gfnet__dense_activation_silu__prompt_kernel
.p2align 8
.type adaLN_cond__spectral_gfnet__dense_activation_silu__prompt_kernel,@function
adaLN_cond__spectral_gfnet__dense_activation_silu__prompt_kernel:
  s_getpc_b64 s[86:87]
  s_cmp_ge_u32 s2, 256
  s_cbranch_scc1 k_done
  s_load_dwordx2 s[4:5], s[0:1], 80
  s_load_dwordx2 s[90:91], s[0:1], 72
  s_load_dwordx4 s[8:11], s[0:1], 48
  v_lshrrev_b32 v1, 6, v0
  s_nop 0
  v_readfirstlane_b32 s95, v1
  s_waitcnt lgkmcnt(0)
  s_cmp_ge_u32 s2, 48
  s_cbranch_scc1 modi_end
  v_lshrrev_b32 v1, 3, v0
  v_and_b32 v2, 7, v0
  v_lshlrev_b32 v3, 1, v1
  s_movk_i32 s24, 6144
  v_mul_lo_u32 v4, v1, s24
  s_lshl_b32 s25, s2, 7
  v_lshl_add_u32 v4, v2, 4, v4
  v_add_u32 v4, s25, v4
  s_mov_b32 s12, s8
  s_mov_b32 s13, s9
  s_mov_b32 s14, 0x400
  s_mov_b32 s15, 0x00020000
  s_mov_b32 s16, s10
  s_mov_b32 s17, s11
  s_mov_b32 s18, 0x300000
  s_mov_b32 s19, 0x00020000
  s_mov_b32 s20, s4
  s_mov_b32 s21, s5
  s_mov_b32 s22, 0x3000
  s_mov_b32 s23, 0x00020000
  buffer_load_ushort v16, v3, s[12:15], 0 offen offset:0
  buffer_load_ushort v17, v3, s[12:15], 0 offen offset:128
  buffer_load_ushort v18, v3, s[12:15], 0 offen offset:256
  buffer_load_ushort v19, v3, s[12:15], 0 offen offset:384
  buffer_load_ushort v20, v3, s[12:15], 0 offen offset:512
  buffer_load_ushort v21, v3, s[12:15], 0 offen offset:640
  buffer_load_ushort v22, v3, s[12:15], 0 offen offset:768
  buffer_load_ushort v23, v3, s[12:15], 0 offen offset:896
  s_mov_b32 s26, 0
  buffer_load_dwordx4 v[32:35], v4, s[16:19], s26 offen
  s_add_u32 s26, s26, 393216
  buffer_load_dwordx4 v[36:39], v4, s[16:19], s26 offen
  s_add_u32 s26, s26, 393216
  buffer_load_dwordx4 v[40:43], v4, s[16:19], s26 offen
  s_add_u32 s26, s26, 393216
  buffer_load_dwordx4 v[44:47], v4, s[16:19], s26 offen
  s_add_u32 s26, s26, 393216
  buffer_load_dwordx4 v[48:51], v4, s[16:19], s26 offen
  s_add_u32 s26, s26, 393216
  buffer_load_dwordx4 v[52:55], v4, s[16:19], s26 offen
  s_add_u32 s26, s26, 393216
  buffer_load_dwordx4 v[56:59], v4, s[16:19], s26 offen
  s_add_u32 s26, s26, 393216
  buffer_load_dwordx4 v[60:63], v4, s[16:19], s26 offen
  s_add_u32 s26, s26, 393216
modi_end:
  s_mov_b32 s96, s90
  s_mov_b32 s97, s91
  s_mov_b32 s98, 0x100
  s_mov_b32 s99, 0x00020000
  s_add_u32 s76, s4, 0xc000
  s_addc_u32 s77, s5, 0
  s_mov_b32 s78, 0x4000
  s_mov_b32 s79, 0x00020000
  s_lshl_b32 s94, s2, 6
  v_mov_b32 v255, s94
  v_mov_b32 v254, 0
  buffer_store_dword v254, v255, s[76:79], 0 offen sc1
  s_add_u32 s64, s4, 0x1890000
  s_addc_u32 s65, s5, 0
  s_mov_b32 s66, 0x4000
  s_mov_b32 s67, 0x00020000
  buffer_store_dword v254, v255, s[64:67], 0 offen sc1
  s_cmp_lg_u32 s95, 0
  s_cbranch_scc1 no_rank
  s_getreg_b32 s68, hwreg(HW_REG_XCC_ID, 0, 4)
  s_and_b32 s68, s68, 7
  s_and_b32 s94, s68, 3
  s_lshl_b32 s94, s94, 6
  s_lshr_b32 s3, s68, 2
  s_lshl_b32 s3, s3, 2
  s_add_u32 s94, s94, s3
  s_add_u32 s94, s94, 8
  s_mov_b64 s[92:93], exec
  s_mov_b64 exec, 1
  v_mov_b32 v255, s94
  v_mov_b32 v239, 1
  buffer_atomic_add v239, v255, s[96:99], 0 offen sc0 sc1
  s_mov_b64 exec, s[92:93]
no_rank:
  s_cmp_ge_u32 s2, 48
  s_cbranch_scc1 mod_end
  v_mov_b32 v8, 0
  v_mov_b32 v9, 0
  v_mov_b32 v10, 0
  v_mov_b32 v11, 0
  v_mov_b32 v12, 0
  v_mov_b32 v13, 0
  v_mov_b32 v14, 0
  v_mov_b32 v15, 0
  s_waitcnt vmcnt(0)
  v_lshlrev_b32 v16, 16, v16
  v_mul_f32 v24, 0xbfb8aa3b, v16
  v_lshlrev_b32 v17, 16, v17
  v_mul_f32 v25, 0xbfb8aa3b, v17
  v_lshlrev_b32 v18, 16, v18
  v_mul_f32 v26, 0xbfb8aa3b, v18
  v_lshlrev_b32 v19, 16, v19
  v_mul_f32 v27, 0xbfb8aa3b, v19
  v_lshlrev_b32 v20, 16, v20
  v_mul_f32 v28, 0xbfb8aa3b, v20
  v_lshlrev_b32 v21, 16, v21
  v_mul_f32 v29, 0xbfb8aa3b, v21
  v_lshlrev_b32 v22, 16, v22
  v_mul_f32 v30, 0xbfb8aa3b, v22
  v_lshlrev_b32 v23, 16, v23
  v_mul_f32 v31, 0xbfb8aa3b, v23
  v_exp_f32 v24, v24
  v_exp_f32 v25, v25
  v_exp_f32 v26, v26
  v_exp_f32 v27, v27
  v_exp_f32 v28, v28
  v_exp_f32 v29, v29
  v_exp_f32 v30, v30
  v_exp_f32 v31, v31
  v_add_f32 v24, 1.0, v24
  v_add_f32 v25, 1.0, v25
  v_add_f32 v26, 1.0, v26
  v_add_f32 v27, 1.0, v27
  v_add_f32 v28, 1.0, v28
  v_add_f32 v29, 1.0, v29
  v_add_f32 v30, 1.0, v30
  v_add_f32 v31, 1.0, v31
  v_rcp_f32 v24, v24
  v_rcp_f32 v25, v25
  v_rcp_f32 v26, v26
  v_rcp_f32 v27, v27
  v_rcp_f32 v28, v28
  v_rcp_f32 v29, v29
  v_rcp_f32 v30, v30
  v_rcp_f32 v31, v31
  v_mul_f32 v16, v16, v24
  v_mul_f32 v17, v17, v25
  v_mul_f32 v18, v18, v26
  v_mul_f32 v19, v19, v27
  v_mul_f32 v20, v20, v28
  v_mul_f32 v21, v21, v29
  v_mul_f32 v22, v22, v30
  v_mul_f32 v23, v23, v31
  v_cvt_pk_bf16_f32 v16, v16, v16
  v_lshlrev_b32 v16, 16, v16
  v_cvt_pk_bf16_f32 v17, v17, v17
  v_lshlrev_b32 v17, 16, v17
  v_cvt_pk_bf16_f32 v18, v18, v18
  v_lshlrev_b32 v18, 16, v18
  v_cvt_pk_bf16_f32 v19, v19, v19
  v_lshlrev_b32 v19, 16, v19
  v_cvt_pk_bf16_f32 v20, v20, v20
  v_lshlrev_b32 v20, 16, v20
  v_cvt_pk_bf16_f32 v21, v21, v21
  v_lshlrev_b32 v21, 16, v21
  v_cvt_pk_bf16_f32 v22, v22, v22
  v_lshlrev_b32 v22, 16, v22
  v_cvt_pk_bf16_f32 v23, v23, v23
  v_lshlrev_b32 v23, 16, v23
  v_mov_b32 v7, v16
  v_mov_b32 v6, v16
  v_lshlrev_b32 v4, 16, v32
  v_and_b32 v5, 0xffff0000, v32
  v_pk_fma_f32 v[8:9], v[4:5], v[6:7], v[8:9]
  v_lshlrev_b32 v4, 16, v33
  v_and_b32 v5, 0xffff0000, v33
  v_pk_fma_f32 v[10:11], v[4:5], v[6:7], v[10:11]
  v_lshlrev_b32 v4, 16, v34
  v_and_b32 v5, 0xffff0000, v34
  v_pk_fma_f32 v[12:13], v[4:5], v[6:7], v[12:13]
  v_lshlrev_b32 v4, 16, v35
  v_and_b32 v5, 0xffff0000, v35
  v_pk_fma_f32 v[14:15], v[4:5], v[6:7], v[14:15]
  v_mov_b32 v7, v17
  v_mov_b32 v6, v17
  v_lshlrev_b32 v4, 16, v36
  v_and_b32 v5, 0xffff0000, v36
  v_pk_fma_f32 v[8:9], v[4:5], v[6:7], v[8:9]
  v_lshlrev_b32 v4, 16, v37
  v_and_b32 v5, 0xffff0000, v37
  v_pk_fma_f32 v[10:11], v[4:5], v[6:7], v[10:11]
  v_lshlrev_b32 v4, 16, v38
  v_and_b32 v5, 0xffff0000, v38
  v_pk_fma_f32 v[12:13], v[4:5], v[6:7], v[12:13]
  v_lshlrev_b32 v4, 16, v39
  v_and_b32 v5, 0xffff0000, v39
  v_pk_fma_f32 v[14:15], v[4:5], v[6:7], v[14:15]
  v_mov_b32 v7, v18
  v_mov_b32 v6, v18
  v_lshlrev_b32 v4, 16, v40
  v_and_b32 v5, 0xffff0000, v40
  v_pk_fma_f32 v[8:9], v[4:5], v[6:7], v[8:9]
  v_lshlrev_b32 v4, 16, v41
  v_and_b32 v5, 0xffff0000, v41
  v_pk_fma_f32 v[10:11], v[4:5], v[6:7], v[10:11]
  v_lshlrev_b32 v4, 16, v42
  v_and_b32 v5, 0xffff0000, v42
  v_pk_fma_f32 v[12:13], v[4:5], v[6:7], v[12:13]
  v_lshlrev_b32 v4, 16, v43
  v_and_b32 v5, 0xffff0000, v43
  v_pk_fma_f32 v[14:15], v[4:5], v[6:7], v[14:15]
  v_mov_b32 v7, v19
  v_mov_b32 v6, v19
  v_lshlrev_b32 v4, 16, v44
  v_and_b32 v5, 0xffff0000, v44
  v_pk_fma_f32 v[8:9], v[4:5], v[6:7], v[8:9]
  v_lshlrev_b32 v4, 16, v45
  v_and_b32 v5, 0xffff0000, v45
  v_pk_fma_f32 v[10:11], v[4:5], v[6:7], v[10:11]
  v_lshlrev_b32 v4, 16, v46
  v_and_b32 v5, 0xffff0000, v46
  v_pk_fma_f32 v[12:13], v[4:5], v[6:7], v[12:13]
  v_lshlrev_b32 v4, 16, v47
  v_and_b32 v5, 0xffff0000, v47
  v_pk_fma_f32 v[14:15], v[4:5], v[6:7], v[14:15]
  v_mov_b32 v7, v20
  v_mov_b32 v6, v20
  v_lshlrev_b32 v4, 16, v48
  v_and_b32 v5, 0xffff0000, v48
  v_pk_fma_f32 v[8:9], v[4:5], v[6:7], v[8:9]
  v_lshlrev_b32 v4, 16, v49
  v_and_b32 v5, 0xffff0000, v49
  v_pk_fma_f32 v[10:11], v[4:5], v[6:7], v[10:11]
  v_lshlrev_b32 v4, 16, v50
  v_and_b32 v5, 0xffff0000, v50
  v_pk_fma_f32 v[12:13], v[4:5], v[6:7], v[12:13]
  v_lshlrev_b32 v4, 16, v51
  v_and_b32 v5, 0xffff0000, v51
  v_pk_fma_f32 v[14:15], v[4:5], v[6:7], v[14:15]
  v_mov_b32 v7, v21
  v_mov_b32 v6, v21
  v_lshlrev_b32 v4, 16, v52
  v_and_b32 v5, 0xffff0000, v52
  v_pk_fma_f32 v[8:9], v[4:5], v[6:7], v[8:9]
  v_lshlrev_b32 v4, 16, v53
  v_and_b32 v5, 0xffff0000, v53
  v_pk_fma_f32 v[10:11], v[4:5], v[6:7], v[10:11]
  v_lshlrev_b32 v4, 16, v54
  v_and_b32 v5, 0xffff0000, v54
  v_pk_fma_f32 v[12:13], v[4:5], v[6:7], v[12:13]
  v_lshlrev_b32 v4, 16, v55
  v_and_b32 v5, 0xffff0000, v55
  v_pk_fma_f32 v[14:15], v[4:5], v[6:7], v[14:15]
  v_mov_b32 v7, v22
  v_mov_b32 v6, v22
  v_lshlrev_b32 v4, 16, v56
  v_and_b32 v5, 0xffff0000, v56
  v_pk_fma_f32 v[8:9], v[4:5], v[6:7], v[8:9]
  v_lshlrev_b32 v4, 16, v57
  v_and_b32 v5, 0xffff0000, v57
  v_pk_fma_f32 v[10:11], v[4:5], v[6:7], v[10:11]
  v_lshlrev_b32 v4, 16, v58
  v_and_b32 v5, 0xffff0000, v58
  v_pk_fma_f32 v[12:13], v[4:5], v[6:7], v[12:13]
  v_lshlrev_b32 v4, 16, v59
  v_and_b32 v5, 0xffff0000, v59
  v_pk_fma_f32 v[14:15], v[4:5], v[6:7], v[14:15]
  v_mov_b32 v7, v23
  v_mov_b32 v6, v23
  v_lshlrev_b32 v4, 16, v60
  v_and_b32 v5, 0xffff0000, v60
  v_pk_fma_f32 v[8:9], v[4:5], v[6:7], v[8:9]
  v_lshlrev_b32 v4, 16, v61
  v_and_b32 v5, 0xffff0000, v61
  v_pk_fma_f32 v[10:11], v[4:5], v[6:7], v[10:11]
  v_lshlrev_b32 v4, 16, v62
  v_and_b32 v5, 0xffff0000, v62
  v_pk_fma_f32 v[12:13], v[4:5], v[6:7], v[12:13]
  v_lshlrev_b32 v4, 16, v63
  v_and_b32 v5, 0xffff0000, v63
  v_pk_fma_f32 v[14:15], v[4:5], v[6:7], v[14:15]
  v_lshlrev_b32 v5, 8, v1
  v_lshl_add_u32 v5, v2, 5, v5
  ds_write_b128 v5, v[8:11]
  ds_write_b128 v5, v[12:15] offset:16
  s_waitcnt lgkmcnt(0)
  s_barrier
  s_cmp_lg_u32 s95, 0
  s_cbranch_scc1 mod_end
  v_lshlrev_b32 v5, 2, v0
  ds_read_b32 v32, v5 offset:0
  ds_read_b32 v33, v5 offset:256
  ds_read_b32 v34, v5 offset:512
  ds_read_b32 v35, v5 offset:768
  ds_read_b32 v36, v5 offset:1024
  ds_read_b32 v37, v5 offset:1280
  ds_read_b32 v38, v5 offset:1536
  ds_read_b32 v39, v5 offset:1792
  ds_read_b32 v40, v5 offset:2048
  ds_read_b32 v41, v5 offset:2304
  ds_read_b32 v42, v5 offset:2560
  ds_read_b32 v43, v5 offset:2816
  ds_read_b32 v44, v5 offset:3072
  ds_read_b32 v45, v5 offset:3328
  ds_read_b32 v46, v5 offset:3584
  ds_read_b32 v47, v5 offset:3840
  ds_read_b32 v48, v5 offset:4096
  ds_read_b32 v49, v5 offset:4352
  ds_read_b32 v50, v5 offset:4608
  ds_read_b32 v51, v5 offset:4864
  ds_read_b32 v52, v5 offset:5120
  ds_read_b32 v53, v5 offset:5376
  ds_read_b32 v54, v5 offset:5632
  ds_read_b32 v55, v5 offset:5888
  ds_read_b32 v56, v5 offset:6144
  ds_read_b32 v57, v5 offset:6400
  ds_read_b32 v58, v5 offset:6656
  ds_read_b32 v59, v5 offset:6912
  ds_read_b32 v60, v5 offset:7168
  ds_read_b32 v61, v5 offset:7424
  ds_read_b32 v62, v5 offset:7680
  ds_read_b32 v63, v5 offset:7936
  ds_read_b32 v64, v5 offset:8192
  ds_read_b32 v65, v5 offset:8448
  ds_read_b32 v66, v5 offset:8704
  ds_read_b32 v67, v5 offset:8960
  ds_read_b32 v68, v5 offset:9216
  ds_read_b32 v69, v5 offset:9472
  ds_read_b32 v70, v5 offset:9728
  ds_read_b32 v71, v5 offset:9984
  ds_read_b32 v72, v5 offset:10240
  ds_read_b32 v73, v5 offset:10496
  ds_read_b32 v74, v5 offset:10752
  ds_read_b32 v75, v5 offset:11008
  ds_read_b32 v76, v5 offset:11264
  ds_read_b32 v77, v5 offset:11520
  ds_read_b32 v78, v5 offset:11776
  ds_read_b32 v79, v5 offset:12032
  ds_read_b32 v80, v5 offset:12288
  ds_read_b32 v81, v5 offset:12544
  ds_read_b32 v82, v5 offset:12800
  ds_read_b32 v83, v5 offset:13056
  ds_read_b32 v84, v5 offset:13312
  ds_read_b32 v85, v5 offset:13568
  ds_read_b32 v86, v5 offset:13824
  ds_read_b32 v87, v5 offset:14080
  ds_read_b32 v88, v5 offset:14336
  ds_read_b32 v89, v5 offset:14592
  ds_read_b32 v90, v5 offset:14848
  ds_read_b32 v91, v5 offset:15104
  ds_read_b32 v92, v5 offset:15360
  ds_read_b32 v93, v5 offset:15616
  ds_read_b32 v94, v5 offset:15872
  ds_read_b32 v95, v5 offset:16128
  s_waitcnt lgkmcnt(0)
  v_pk_add_f32 v[32:33], v[32:33], v[64:65]
  v_pk_add_f32 v[34:35], v[34:35], v[66:67]
  v_pk_add_f32 v[36:37], v[36:37], v[68:69]
  v_pk_add_f32 v[38:39], v[38:39], v[70:71]
  v_pk_add_f32 v[40:41], v[40:41], v[72:73]
  v_pk_add_f32 v[42:43], v[42:43], v[74:75]
  v_pk_add_f32 v[44:45], v[44:45], v[76:77]
  v_pk_add_f32 v[46:47], v[46:47], v[78:79]
  v_pk_add_f32 v[48:49], v[48:49], v[80:81]
  v_pk_add_f32 v[50:51], v[50:51], v[82:83]
  v_pk_add_f32 v[52:53], v[52:53], v[84:85]
  v_pk_add_f32 v[54:55], v[54:55], v[86:87]
  v_pk_add_f32 v[56:57], v[56:57], v[88:89]
  v_pk_add_f32 v[58:59], v[58:59], v[90:91]
  v_pk_add_f32 v[60:61], v[60:61], v[92:93]
  v_pk_add_f32 v[62:63], v[62:63], v[94:95]
  v_pk_add_f32 v[32:33], v[32:33], v[48:49]
  v_pk_add_f32 v[34:35], v[34:35], v[50:51]
  v_pk_add_f32 v[36:37], v[36:37], v[52:53]
  v_pk_add_f32 v[38:39], v[38:39], v[54:55]
  v_pk_add_f32 v[40:41], v[40:41], v[56:57]
  v_pk_add_f32 v[42:43], v[42:43], v[58:59]
  v_pk_add_f32 v[44:45], v[44:45], v[60:61]
  v_pk_add_f32 v[46:47], v[46:47], v[62:63]
  v_pk_add_f32 v[32:33], v[32:33], v[40:41]
  v_pk_add_f32 v[34:35], v[34:35], v[42:43]
  v_pk_add_f32 v[36:37], v[36:37], v[44:45]
  v_pk_add_f32 v[38:39], v[38:39], v[46:47]
  v_pk_add_f32 v[32:33], v[32:33], v[36:37]
  v_pk_add_f32 v[34:35], v[34:35], v[38:39]
  v_pk_add_f32 v[32:33], v[32:33], v[34:35]
  v_add_f32 v32, v32, v33
  v_cvt_pk_bf16_f32 v32, v32, v32
  v_lshlrev_b32 v32, 16, v32
  s_lshr_b32 s26, s2, 3
  s_cmp_eq_u32 s26, 1
  s_cselect_b32 s27, 1, 0
  s_cmp_eq_u32 s26, 4
  s_cselect_b32 s27, 1, s27
  s_cmp_eq_u32 s27, 0
  s_cbranch_scc1 mod_st
  v_add_f32 v32, 1.0, v32
  v_cvt_pk_bf16_f32 v32, v32, v32
  v_lshlrev_b32 v32, 16, v32
mod_st:
  s_lshl_b32 s26, s2, 8
  v_add_u32 v5, s26, v5
  buffer_store_dword v32, v5, s[20:23], 0 offen sc1
mod_end:
  s_cmp_ge_u32 s95, 4
  s_cbranch_scc1 helper
  s_waitcnt vmcnt(0) lgkmcnt(0)
  s_cmp_lg_u32 s95, 0
  s_cbranch_scc1 arr_skip_a
  s_mov_b64 s[92:93], exec
  s_mov_b64 exec, 1
  s_and_b32 s94, s2, 3
  s_lshl_b32 s94, s94, 6
  v_mov_b32 v255, s94
  v_mov_b32 v254, 1
  buffer_atomic_add v254, v255, s[96:99], 0 offen sc1
  s_cmp_ge_u32 s2, 16
  s_cbranch_scc1 arr_no16
  v_mov_b32 v255, 16
  buffer_atomic_add v254, v255, s[96:99], 0 offen sc1
arr_no16:
  s_mov_b64 exec, s[92:93]
arr_skip_a:
  s_load_dwordx2 s[6:7], s[0:1], 0
  v_and_b32 v1, 31, v0
  v_lshrrev_b32 v2, 5, v0
  s_lshl_b32 s3, s2, 13
  v_lshl_add_u32 v3, v2, 10, s3
  v_lshl_add_u32 v3, v1, 2, v3
  s_waitcnt lgkmcnt(0)
  s_mov_b32 s8, s6
  s_mov_b32 s9, s7
  s_mov_b32 s10, 0x200000
  s_mov_b32 s11, 0x00020000
  buffer_load_dword v240, v3, s[8:11], 0 offen offset:0
  buffer_load_dword v241, v3, s[8:11], 0 offen offset:128
  buffer_load_dword v242, v3, s[8:11], 0 offen offset:256
  buffer_load_dword v243, v3, s[8:11], 0 offen offset:384
  buffer_load_dword v244, v3, s[8:11], 0 offen offset:512
  buffer_load_dword v245, v3, s[8:11], 0 offen offset:640
  buffer_load_dword v246, v3, s[8:11], 0 offen offset:768
  buffer_load_dword v247, v3, s[8:11], 0 offen offset:896
  s_cmp_lt_u32 s2, 48
  s_cbranch_scc1 m_nowt
  s_sub_u32 s70, s2, 48
  s_load_dwordx4 s[8:11], s[0:1], 8
  s_waitcnt lgkmcnt(0)
  s_mov_b32 s12, s8
  s_mov_b32 s13, s9
  s_mov_b32 s14, 0x101000
  s_mov_b32 s15, 0x00020000
  s_mov_b32 s16, s10
  s_mov_b32 s17, s11
  s_mov_b32 s18, 0x101000
  s_mov_b32 s19, 0x00020000
  s_add_u32 s20, s4, 0x10000
  s_addc_u32 s21, s5, 0
  s_mov_b32 s22, 0x200000
  s_mov_b32 s23, 0x00020000
  s_and_b32 s25, s70, 7
  s_lshr_b32 s26, s70, 3
  s_and_b32 s27, s26, 7
  s_lshr_b32 s26, s26, 3
  v_and_b32 v1, 63, v0
  s_lshl_b32 s28, s26, 6
  v_add_u32 v1, s28, v1
  v_lshrrev_b32 v2, 6, v0
  s_lshr_b32 s29, s25, 1
  s_lshl_b32 s29, s29, 9
  s_and_b32 s32, s25, 1
  s_lshl_b32 s32, s32, 6
  s_add_u32 s29, s29, s32
  s_add_u32 s29, s29, s27
  v_lshl_add_u32 v3, v2, 3, s29
  s_movk_i32 s33, 514
  v_mul_lo_u32 v3, v3, s33
  v_lshl_add_u32 v3, v1, 1, v3
  s_mov_b32 s34, 0
  buffer_load_ushort v8, v3, s[12:15], s34 offen
  buffer_load_ushort v12, v3, s[16:19], s34 offen
  s_mov_b32 s34, 65792
  buffer_load_ushort v9, v3, s[12:15], s34 offen
  buffer_load_ushort v13, v3, s[16:19], s34 offen
  s_mov_b32 s34, 131584
  buffer_load_ushort v10, v3, s[12:15], s34 offen
  buffer_load_ushort v14, v3, s[16:19], s34 offen
  s_mov_b32 s34, 197376
  buffer_load_ushort v11, v3, s[12:15], s34 offen
  buffer_load_ushort v15, v3, s[16:19], s34 offen
  s_mov_b32 s34, 16448
  buffer_load_ushort v16, v3, s[12:15], s34 offen
  buffer_load_ushort v20, v3, s[16:19], s34 offen
  s_mov_b32 s34, 82240
  buffer_load_ushort v17, v3, s[12:15], s34 offen
  buffer_load_ushort v21, v3, s[16:19], s34 offen
  s_mov_b32 s34, 148032
  buffer_load_ushort v18, v3, s[12:15], s34 offen
  buffer_load_ushort v22, v3, s[16:19], s34 offen
  s_mov_b32 s34, 213824
  buffer_load_ushort v19, v3, s[12:15], s34 offen
  buffer_load_ushort v23, v3, s[16:19], s34 offen
  v_lshlrev_b32 v4, 13, v1
  s_lshl_b32 s35, s25, 10
  s_lshl_b32 s36, s27, 7
  s_add_u32 s35, s35, s36
  v_add_u32 v4, s35, v4
  v_lshl_add_u32 v4, v2, 4, v4
  s_waitcnt vmcnt(0)
  v_lshl_or_b32 v8, v12, 16, v8
  v_lshl_or_b32 v9, v13, 16, v9
  v_lshl_or_b32 v10, v14, 16, v10
  v_lshl_or_b32 v11, v15, 16, v11
  v_lshl_or_b32 v16, v20, 16, v16
  v_lshl_or_b32 v17, v21, 16, v17
  v_lshl_or_b32 v18, v22, 16, v18
  v_lshl_or_b32 v19, v23, 16, v19
  buffer_store_dwordx4 v[8:11], v4, s[20:23], 0 offen sc1
  buffer_store_dwordx4 v[16:19], v4, s[20:23], 0 offen offset:64 sc1
m_nowt:
  s_mov_b32 s60, 0x3f3504f3
  s_mov_b32 s61, 0x3f3504f3
  v_and_b32 v1, 31, v0
  v_lshrrev_b32 v2, 5, v0
  v_lshlrev_b32 v4, 3, v1
  s_mov_b32 s12, s4
  s_mov_b32 s13, s5
  s_mov_b32 s14, 0x3000
  s_mov_b32 s15, 0x00020000
  s_add_u32 s16, s4, 0x590000
  s_addc_u32 s17, s5, 0
  s_mov_b32 s18, 0x400000
  s_mov_b32 s19, 0x00020000
  v_cvt_f32_u32 v5, v1
  v_mul_f32 v5, 0x3b800000, v5
  v_cos_f32 v80, v5
  v_sin_f32 v81, -v5
  v_mul_f32 v6, 2.0, v5
  v_cos_f32 v82, v6
  v_sin_f32 v83, -v6
  v_mul_f32 v6, 0x40400000, v5
  v_cos_f32 v84, v6
  v_sin_f32 v85, -v6
  v_mul_f32 v6, 4.0, v5
  v_cos_f32 v86, v6
  v_sin_f32 v87, -v6
  v_mul_f32 v6, 0x40a00000, v5
  v_cos_f32 v88, v6
  v_sin_f32 v89, -v6
  v_mul_f32 v6, 0x40c00000, v5
  v_cos_f32 v90, v6
  v_sin_f32 v91, -v6
  v_mul_f32 v6, 0x40e00000, v5
  v_cos_f32 v92, v6
  v_sin_f32 v93, -v6
  v_and_b32 v7, 3, v0
  v_cvt_f32_u32 v5, v7
  v_mul_f32 v5, 0x3d000000, v5
  v_cos_f32 v94, v5
  v_sin_f32 v95, -v5
  v_mul_f32 v6, 2.0, v5
  v_cos_f32 v96, v6
  v_sin_f32 v97, -v6
  v_mul_f32 v6, 0x40400000, v5
  v_cos_f32 v98, v6
  v_sin_f32 v99, -v6
  v_mul_f32 v6, 4.0, v5
  v_cos_f32 v100, v6
  v_sin_f32 v101, -v6
  v_mul_f32 v6, 0x40a00000, v5
  v_cos_f32 v102, v6
  v_sin_f32 v103, -v6
  v_mul_f32 v6, 0x40c00000, v5
  v_cos_f32 v104, v6
  v_sin_f32 v105, -v6
  v_mul_f32 v6, 0x40e00000, v5
  v_cos_f32 v106, v6
  v_sin_f32 v107, -v6
  v_lshrrev_b32 v8, 3, v0
  v_cvt_f32_u32 v5, v8
  v_mul_f32 v5, 0x3b000000, v5
  v_add_f32 v6, 0x00000000, v5
  v_cos_f32 v108, v6
  v_sin_f32 v109, -v6
  v_add_f32 v6, 0x3e000000, v5
  v_cos_f32 v110, v6
  v_sin_f32 v111, -v6
  v_add_f32 v6, 0x3e800000, v5
  v_cos_f32 v112, v6
  v_sin_f32 v113, -v6
  v_add_f32 v6, 0x3ec00000, v5
  v_cos_f32 v114, v6
  v_sin_f32 v115, -v6
  v_mul_u32_u24 v9, 2304, v2
  v_lshl_add_u32 v10, v1, 3, v9
  v_bfe_u32 v11, v0, 2, 3
  v_mul_u32_u24 v12, 288, v11
  v_add_u32 v12, v12, v9
  v_lshl_add_u32 v12, v7, 3, v12
  v_mul_u32_u24 v13, 2064, v2
  v_lshl_add_u32 v13, v11, 5, v13
  v_lshl_add_u32 v13, v7, 3, v13
  v_add_u32 v13, 18432, v13
  s_waitcnt vmcnt(0)
  v_lshlrev_b32 v16, 16, v240
  v_and_b32 v17, 0xffff0000, v240
  v_lshlrev_b32 v18, 16, v241
  v_and_b32 v19, 0xffff0000, v241
  v_lshlrev_b32 v20, 16, v242
  v_and_b32 v21, 0xffff0000, v242
  v_lshlrev_b32 v22, 16, v243
  v_and_b32 v23, 0xffff0000, v243
  v_lshlrev_b32 v24, 16, v244
  v_and_b32 v25, 0xffff0000, v244
  v_lshlrev_b32 v26, 16, v245
  v_and_b32 v27, 0xffff0000, v245
  v_lshlrev_b32 v28, 16, v246
  v_and_b32 v29, 0xffff0000, v246
  v_lshlrev_b32 v30, 16, v247
  v_and_b32 v31, 0xffff0000, v247
  s_cmp_lg_u32 s95, 0
  s_cbranch_scc1 wait_skip_a
  v_and_b32 v253, 63, v0
  v_lshlrev_b32 v253, 6, v253
  s_mov_b64 s[92:93], exec
  s_mov_b64 exec, 1
  v_mov_b32 v253, 16
wait_loop_a:
  buffer_load_dword v254, v253, s[96:99], 0 offen sc1
  s_waitcnt vmcnt(0)
  v_cmp_gt_u32 vcc, 16, v254
  s_cmp_eq_u64 vcc, 0
  s_cbranch_scc1 wait_out_a
  s_sleep 6
  s_branch wait_loop_a
wait_out_a:
  s_mov_b64 exec, s[92:93]
wait_skip_a:
  s_barrier
  buffer_load_dwordx2 v[64:65], v4, s[12:15], 0 offen offset:0
  buffer_load_dwordx2 v[48:49], v4, s[12:15], 0 offen offset:2048
  buffer_load_dwordx2 v[66:67], v4, s[12:15], 0 offen offset:256
  buffer_load_dwordx2 v[50:51], v4, s[12:15], 0 offen offset:2304
  buffer_load_dwordx2 v[68:69], v4, s[12:15], 0 offen offset:512
  buffer_load_dwordx2 v[52:53], v4, s[12:15], 0 offen offset:2560
  buffer_load_dwordx2 v[70:71], v4, s[12:15], 0 offen offset:768
  buffer_load_dwordx2 v[54:55], v4, s[12:15], 0 offen offset:2816
  buffer_load_dwordx2 v[72:73], v4, s[12:15], 0 offen offset:1024
  buffer_load_dwordx2 v[56:57], v4, s[12:15], 0 offen offset:3072
  buffer_load_dwordx2 v[74:75], v4, s[12:15], 0 offen offset:1280
  buffer_load_dwordx2 v[58:59], v4, s[12:15], 0 offen offset:3328
  buffer_load_dwordx2 v[76:77], v4, s[12:15], 0 offen offset:1536
  buffer_load_dwordx2 v[60:61], v4, s[12:15], 0 offen offset:3584
  buffer_load_dwordx2 v[78:79], v4, s[12:15], 0 offen offset:1792
  buffer_load_dwordx2 v[62:63], v4, s[12:15], 0 offen offset:3840
  s_waitcnt vmcnt(0)
  v_pk_add_f32 v[124:125], v[16:17], v[18:19]
  v_pk_add_f32 v[124:125], v[124:125], v[20:21]
  v_pk_add_f32 v[124:125], v[124:125], v[22:23]
  v_pk_add_f32 v[124:125], v[124:125], v[24:25]
  v_pk_add_f32 v[124:125], v[124:125], v[26:27]
  v_pk_add_f32 v[124:125], v[124:125], v[28:29]
  v_pk_add_f32 v[124:125], v[124:125], v[30:31]
  v_add_f32 v120, v124, v125
  s_nop 1
  v_add_f32_dpp v120, v120, v120 quad_perm:[1,0,3,2] row_mask:0xf bank_mask:0xf
  s_nop 1
  v_add_f32_dpp v120, v120, v120 quad_perm:[2,3,0,1] row_mask:0xf bank_mask:0xf
  s_nop 1
  v_add_f32_dpp v120, v120, v120 row_half_mirror row_mask:0xf bank_mask:0xf
  s_nop 1
  v_add_f32_dpp v120, v120, v120 row_mirror row_mask:0xf bank_mask:0xf
  v_mov_b32 v121, v120
  s_nop 1
  v_permlane16_swap_b32 v120, v121
  s_nop 1
  v_add_f32 v120, v120, v121
  v_mul_f32 v120, 0x3b000000, v120
  v_mov_b32 v121, v120
  v_mov_b32 v122, 0
  v_mov_b32 v123, 0
  v_pk_add_f32 v[124:125], v[16:17], v[120:121] neg_lo:[0,1] neg_hi:[0,1]
  v_pk_fma_f32 v[122:123], v[124:125], v[124:125], v[122:123]
  v_pk_add_f32 v[124:125], v[18:19], v[120:121] neg_lo:[0,1] neg_hi:[0,1]
  v_pk_fma_f32 v[122:123], v[124:125], v[124:125], v[122:123]
  v_pk_add_f32 v[124:125], v[20:21], v[120:121] neg_lo:[0,1] neg_hi:[0,1]
  v_pk_fma_f32 v[122:123], v[124:125], v[124:125], v[122:123]
  v_pk_add_f32 v[124:125], v[22:23], v[120:121] neg_lo:[0,1] neg_hi:[0,1]
  v_pk_fma_f32 v[122:123], v[124:125], v[124:125], v[122:123]
  v_pk_add_f32 v[124:125], v[24:25], v[120:121] neg_lo:[0,1] neg_hi:[0,1]
  v_pk_fma_f32 v[122:123], v[124:125], v[124:125], v[122:123]
  v_pk_add_f32 v[124:125], v[26:27], v[120:121] neg_lo:[0,1] neg_hi:[0,1]
  v_pk_fma_f32 v[122:123], v[124:125], v[124:125], v[122:123]
  v_pk_add_f32 v[124:125], v[28:29], v[120:121] neg_lo:[0,1] neg_hi:[0,1]
  v_pk_fma_f32 v[122:123], v[124:125], v[124:125], v[122:123]
  v_pk_add_f32 v[124:125], v[30:31], v[120:121] neg_lo:[0,1] neg_hi:[0,1]
  v_pk_fma_f32 v[122:123], v[124:125], v[124:125], v[122:123]
  v_add_f32 v122, v122, v123
  s_nop 1
  v_add_f32_dpp v122, v122, v122 quad_perm:[1,0,3,2] row_mask:0xf bank_mask:0xf
  s_nop 1
  v_add_f32_dpp v122, v122, v122 quad_perm:[2,3,0,1] row_mask:0xf bank_mask:0xf
  s_nop 1
  v_add_f32_dpp v122, v122, v122 row_half_mirror row_mask:0xf bank_mask:0xf
  s_nop 1
  v_add_f32_dpp v122, v122, v122 row_mirror row_mask:0xf bank_mask:0xf
  v_mov_b32 v123, v122
  s_nop 1
  v_permlane16_swap_b32 v122, v123
  s_nop 1
  v_add_f32 v122, v122, v123
  v_mul_f32 v122, 0x3b000000, v122
  v_cvt_pk_bf16_f32 v122, v122, v122
  v_lshlrev_b32 v122, 16, v122
  v_add_f32 v122, 0x3727c5ac, v122
  v_cvt_pk_bf16_f32 v122, v122, v122
  v_lshlrev_b32 v122, 16, v122
  v_sqrt_f32 v122, v122
  s_nop 0
  v_cvt_pk_bf16_f32 v122, v122, v122
  v_lshlrev_b32 v122, 16, v122
  v_rcp_f32 v122, v122
  v_cvt_pk_bf16_f32 v120, v120, v120
  v_lshlrev_b32 v120, 16, v120
  v_mov_b32 v121, v120
  v_mov_b32 v123, v122
  v_pk_add_f32 v[16:17], v[16:17], v[120:121] neg_lo:[0,1] neg_hi:[0,1]
  v_cvt_pk_bf16_f32 v124, v16, v17
  v_lshlrev_b32 v16, 16, v124
  v_and_b32 v17, 0xffff0000, v124
  v_pk_mul_f32 v[16:17], v[16:17], v[122:123]
  v_cvt_pk_bf16_f32 v124, v16, v17
  v_lshlrev_b32 v16, 16, v124
  v_and_b32 v17, 0xffff0000, v124
  v_pk_mul_f32 v[16:17], v[16:17], v[48:49]
  v_cvt_pk_bf16_f32 v124, v16, v17
  v_lshlrev_b32 v16, 16, v124
  v_and_b32 v17, 0xffff0000, v124
  v_pk_add_f32 v[16:17], v[16:17], v[64:65]
  v_cvt_pk_bf16_f32 v124, v16, v17
  v_lshlrev_b32 v16, 16, v124
  v_and_b32 v17, 0xffff0000, v124
  v_pk_add_f32 v[18:19], v[18:19], v[120:121] neg_lo:[0,1] neg_hi:[0,1]
  v_cvt_pk_bf16_f32 v124, v18, v19
  v_lshlrev_b32 v18, 16, v124
  v_and_b32 v19, 0xffff0000, v124
  v_pk_mul_f32 v[18:19], v[18:19], v[122:123]
  v_cvt_pk_bf16_f32 v124, v18, v19
  v_lshlrev_b32 v18, 16, v124
  v_and_b32 v19, 0xffff0000, v124
  v_pk_mul_f32 v[18:19], v[18:19], v[50:51]
  v_cvt_pk_bf16_f32 v124, v18, v19
  v_lshlrev_b32 v18, 16, v124
  v_and_b32 v19, 0xffff0000, v124
  v_pk_add_f32 v[18:19], v[18:19], v[66:67]
  v_cvt_pk_bf16_f32 v124, v18, v19
  v_lshlrev_b32 v18, 16, v124
  v_and_b32 v19, 0xffff0000, v124
  v_pk_add_f32 v[20:21], v[20:21], v[120:121] neg_lo:[0,1] neg_hi:[0,1]
  v_cvt_pk_bf16_f32 v124, v20, v21
  v_lshlrev_b32 v20, 16, v124
  v_and_b32 v21, 0xffff0000, v124
  v_pk_mul_f32 v[20:21], v[20:21], v[122:123]
  v_cvt_pk_bf16_f32 v124, v20, v21
  v_lshlrev_b32 v20, 16, v124
  v_and_b32 v21, 0xffff0000, v124
  v_pk_mul_f32 v[20:21], v[20:21], v[52:53]
  v_cvt_pk_bf16_f32 v124, v20, v21
  v_lshlrev_b32 v20, 16, v124
  v_and_b32 v21, 0xffff0000, v124
  v_pk_add_f32 v[20:21], v[20:21], v[68:69]
  v_cvt_pk_bf16_f32 v124, v20, v21
  v_lshlrev_b32 v20, 16, v124
  v_and_b32 v21, 0xffff0000, v124
  v_pk_add_f32 v[22:23], v[22:23], v[120:121] neg_lo:[0,1] neg_hi:[0,1]
  v_cvt_pk_bf16_f32 v124, v22, v23
  v_lshlrev_b32 v22, 16, v124
  v_and_b32 v23, 0xffff0000, v124
  v_pk_mul_f32 v[22:23], v[22:23], v[122:123]
  v_cvt_pk_bf16_f32 v124, v22, v23
  v_lshlrev_b32 v22, 16, v124
  v_and_b32 v23, 0xffff0000, v124
  v_pk_mul_f32 v[22:23], v[22:23], v[54:55]
  v_cvt_pk_bf16_f32 v124, v22, v23
  v_lshlrev_b32 v22, 16, v124
  v_and_b32 v23, 0xffff0000, v124
  v_pk_add_f32 v[22:23], v[22:23], v[70:71]
  v_cvt_pk_bf16_f32 v124, v22, v23
  v_lshlrev_b32 v22, 16, v124
  v_and_b32 v23, 0xffff0000, v124
  v_pk_add_f32 v[24:25], v[24:25], v[120:121] neg_lo:[0,1] neg_hi:[0,1]
  v_cvt_pk_bf16_f32 v124, v24, v25
  v_lshlrev_b32 v24, 16, v124
  v_and_b32 v25, 0xffff0000, v124
  v_pk_mul_f32 v[24:25], v[24:25], v[122:123]
  v_cvt_pk_bf16_f32 v124, v24, v25
  v_lshlrev_b32 v24, 16, v124
  v_and_b32 v25, 0xffff0000, v124
  v_pk_mul_f32 v[24:25], v[24:25], v[56:57]
  v_cvt_pk_bf16_f32 v124, v24, v25
  v_lshlrev_b32 v24, 16, v124
  v_and_b32 v25, 0xffff0000, v124
  v_pk_add_f32 v[24:25], v[24:25], v[72:73]
  v_cvt_pk_bf16_f32 v124, v24, v25
  v_lshlrev_b32 v24, 16, v124
  v_and_b32 v25, 0xffff0000, v124
  v_pk_add_f32 v[26:27], v[26:27], v[120:121] neg_lo:[0,1] neg_hi:[0,1]
  v_cvt_pk_bf16_f32 v124, v26, v27
  v_lshlrev_b32 v26, 16, v124
  v_and_b32 v27, 0xffff0000, v124
  v_pk_mul_f32 v[26:27], v[26:27], v[122:123]
  v_cvt_pk_bf16_f32 v124, v26, v27
  v_lshlrev_b32 v26, 16, v124
  v_and_b32 v27, 0xffff0000, v124
  v_pk_mul_f32 v[26:27], v[26:27], v[58:59]
  v_cvt_pk_bf16_f32 v124, v26, v27
  v_lshlrev_b32 v26, 16, v124
  v_and_b32 v27, 0xffff0000, v124
  v_pk_add_f32 v[26:27], v[26:27], v[74:75]
  v_cvt_pk_bf16_f32 v124, v26, v27
  v_lshlrev_b32 v26, 16, v124
  v_and_b32 v27, 0xffff0000, v124
  v_pk_add_f32 v[28:29], v[28:29], v[120:121] neg_lo:[0,1] neg_hi:[0,1]
  v_cvt_pk_bf16_f32 v124, v28, v29
  v_lshlrev_b32 v28, 16, v124
  v_and_b32 v29, 0xffff0000, v124
  v_pk_mul_f32 v[28:29], v[28:29], v[122:123]
  v_cvt_pk_bf16_f32 v124, v28, v29
  v_lshlrev_b32 v28, 16, v124
  v_and_b32 v29, 0xffff0000, v124
  v_pk_mul_f32 v[28:29], v[28:29], v[60:61]
  v_cvt_pk_bf16_f32 v124, v28, v29
  v_lshlrev_b32 v28, 16, v124
  v_and_b32 v29, 0xffff0000, v124
  v_pk_add_f32 v[28:29], v[28:29], v[76:77]
  v_cvt_pk_bf16_f32 v124, v28, v29
  v_lshlrev_b32 v28, 16, v124
  v_and_b32 v29, 0xffff0000, v124
  v_pk_add_f32 v[30:31], v[30:31], v[120:121] neg_lo:[0,1] neg_hi:[0,1]
  v_cvt_pk_bf16_f32 v124, v30, v31
  v_lshlrev_b32 v30, 16, v124
  v_and_b32 v31, 0xffff0000, v124
  v_pk_mul_f32 v[30:31], v[30:31], v[122:123]
  v_cvt_pk_bf16_f32 v124, v30, v31
  v_lshlrev_b32 v30, 16, v124
  v_and_b32 v31, 0xffff0000, v124
  v_pk_mul_f32 v[30:31], v[30:31], v[62:63]
  v_cvt_pk_bf16_f32 v124, v30, v31
  v_lshlrev_b32 v30, 16, v124
  v_and_b32 v31, 0xffff0000, v124
  v_pk_add_f32 v[30:31], v[30:31], v[78:79]
  v_cvt_pk_bf16_f32 v124, v30, v31
  v_lshlrev_b32 v30, 16, v124
  v_and_b32 v31, 0xffff0000, v124
  v_pk_add_f32 v[32:33], v[16:17], v[24:25]
  v_pk_add_f32 v[24:25], v[16:17], v[24:25] neg_lo:[0,1] neg_hi:[0,1]
  v_pk_add_f32 v[34:35], v[18:19], v[26:27]
  v_pk_add_f32 v[26:27], v[18:19], v[26:27] neg_lo:[0,1] neg_hi:[0,1]
  v_pk_add_f32 v[36:37], v[20:21], v[28:29]
  v_pk_add_f32 v[28:29], v[20:21], v[28:29] neg_lo:[0,1] neg_hi:[0,1]
  v_pk_add_f32 v[38:39], v[22:23], v[30:31]
  v_pk_add_f32 v[30:31], v[22:23], v[30:31] neg_lo:[0,1] neg_hi:[0,1]
  v_pk_add_f32 v[16:17], v[32:33], v[36:37]
  v_pk_add_f32 v[18:19], v[32:33], v[36:37] neg_lo:[0,1] neg_hi:[0,1]
  v_pk_add_f32 v[20:21], v[34:35], v[38:39]
  v_pk_add_f32 v[22:23], v[34:35], v[38:39] neg_lo:[0,1] neg_hi:[0,1]
  v_pk_add_f32 v[32:33], v[16:17], v[20:21]
  v_pk_add_f32 v[34:35], v[16:17], v[20:21] neg_lo:[0,1] neg_hi:[0,1]
  v_pk_add_f32 v[36:37], v[18:19], v[22:23] op_sel:[0,1] op_sel_hi:[1,0] neg_hi:[0,1]
  v_pk_add_f32 v[38:39], v[18:19], v[22:23] op_sel:[0,1] op_sel_hi:[1,0] neg_lo:[0,1]
  v_pk_add_f32 v[16:17], v[24:25], v[28:29] op_sel:[0,1] op_sel_hi:[1,0] neg_hi:[0,1]
  v_pk_add_f32 v[18:19], v[24:25], v[28:29] op_sel:[0,1] op_sel_hi:[1,0] neg_lo:[0,1]
  v_pk_add_f32 v[20:21], v[26:27], v[26:27] op_sel:[0,1] op_sel_hi:[1,0] neg_hi:[0,1]
  v_pk_add_f32 v[22:23], v[30:31], v[30:31] op_sel:[0,1] op_sel_hi:[1,0] neg_lo:[0,1]
  v_pk_add_f32 v[24:25], v[20:21], v[22:23] neg_lo:[0,1] neg_hi:[0,1]
  v_pk_add_f32 v[26:27], v[20:21], v[22:23]
  v_pk_fma_f32 v[28:29], v[24:25], s[60:61], v[16:17]
  v_pk_fma_f32 v[30:31], v[24:25], s[60:61], v[16:17] neg_lo:[1,0,0] neg_hi:[1,0,0]
  v_pk_fma_f32 v[20:21], v[26:27], s[60:61], v[18:19] op_sel:[1,0,0] op_sel_hi:[0,1,1] neg_hi:[1,0,0]
  v_pk_fma_f32 v[22:23], v[26:27], s[60:61], v[18:19] op_sel:[1,0,0] op_sel_hi:[0,1,1] neg_lo:[1,0,0]
  v_pk_mul_f32 v[16:17], v[28:29], v[80:81] op_sel:[0,0] op_sel_hi:[1,0]
  v_pk_fma_f32 v[28:29], v[28:29], v[80:81], v[16:17] op_sel:[1,1,0] op_sel_hi:[0,1,1] neg_lo:[0,1,0]
  v_pk_mul_f32 v[16:17], v[36:37], v[82:83] op_sel:[0,0] op_sel_hi:[1,0]
  v_pk_fma_f32 v[36:37], v[36:37], v[82:83], v[16:17] op_sel:[1,1,0] op_sel_hi:[0,1,1] neg_lo:[0,1,0]
  v_pk_mul_f32 v[16:17], v[20:21], v[84:85] op_sel:[0,0] op_sel_hi:[1,0]
  v_pk_fma_f32 v[20:21], v[20:21], v[84:85], v[16:17] op_sel:[1,1,0] op_sel_hi:[0,1,1] neg_lo:[0,1,0]
  v_pk_mul_f32 v[16:17], v[34:35], v[86:87] op_sel:[0,0] op_sel_hi:[1,0]
  v_pk_fma_f32 v[34:35], v[34:35], v[86:87], v[16:17] op_sel:[1,1,0] op_sel_hi:[0,1,1] neg_lo:[0,1,0]
  v_pk_mul_f32 v[16:17], v[30:31], v[88:89] op_sel:[0,0] op_sel_hi:[1,0]
  v_pk_fma_f32 v[30:31], v[30:31], v[88:89], v[16:17] op_sel:[1,1,0] op_sel_hi:[0,1,1] neg_lo:[0,1,0]
  v_pk_mul_f32 v[16:17], v[38:39], v[90:91] op_sel:[0,0] op_sel_hi:[1,0]
  v_pk_fma_f32 v[38:39], v[38:39], v[90:91], v[16:17] op_sel:[1,1,0] op_sel_hi:[0,1,1] neg_lo:[0,1,0]
  v_pk_mul_f32 v[16:17], v[22:23], v[92:93] op_sel:[0,0] op_sel_hi:[1,0]
  v_pk_fma_f32 v[22:23], v[22:23], v[92:93], v[16:17] op_sel:[1,1,0] op_sel_hi:[0,1,1] neg_lo:[0,1,0]
  ds_write_b64 v10, v[32:33] offset:0
  ds_write_b64 v10, v[28:29] offset:288
  ds_write_b64 v10, v[36:37] offset:576
  ds_write_b64 v10, v[20:21] offset:864
  ds_write_b64 v10, v[34:35] offset:1152
  ds_write_b64 v10, v[30:31] offset:1440
  ds_write_b64 v10, v[38:39] offset:1728
  ds_write_b64 v10, v[22:23] offset:2016
  ds_read_b64 v[32:33], v12 offset:0
  ds_read_b64 v[28:29], v12 offset:32
  ds_read_b64 v[36:37], v12 offset:64
  ds_read_b64 v[20:21], v12 offset:96
  ds_read_b64 v[34:35], v12 offset:128
  ds_read_b64 v[30:31], v12 offset:160
  ds_read_b64 v[38:39], v12 offset:192
  ds_read_b64 v[22:23], v12 offset:224
  s_waitcnt lgkmcnt(0)
  v_pk_add_f32 v[16:17], v[32:33], v[34:35]
  v_pk_add_f32 v[34:35], v[32:33], v[34:35] neg_lo:[0,1] neg_hi:[0,1]
  v_pk_add_f32 v[18:19], v[28:29], v[30:31]
  v_pk_add_f32 v[30:31], v[28:29], v[30:31] neg_lo:[0,1] neg_hi:[0,1]
  v_pk_add_f32 v[24:25], v[36:37], v[38:39]
  v_pk_add_f32 v[38:39], v[36:37], v[38:39] neg_lo:[0,1] neg_hi:[0,1]
  v_pk_add_f32 v[26:27], v[20:21], v[22:23]
  v_pk_add_f32 v[22:23], v[20:21], v[22:23] neg_lo:[0,1] neg_hi:[0,1]
  v_pk_add_f32 v[32:33], v[16:17], v[24:25]
  v_pk_add_f32 v[28:29], v[16:17], v[24:25] neg_lo:[0,1] neg_hi:[0,1]
  v_pk_add_f32 v[36:37], v[18:19], v[26:27]
  v_pk_add_f32 v[20:21], v[18:19], v[26:27] neg_lo:[0,1] neg_hi:[0,1]
  v_pk_add_f32 v[16:17], v[32:33], v[36:37]
  v_pk_add_f32 v[18:19], v[32:33], v[36:37] neg_lo:[0,1] neg_hi:[0,1]
  v_pk_add_f32 v[24:25], v[28:29], v[20:21] op_sel:[0,1] op_sel_hi:[1,0] neg_hi:[0,1]
  v_pk_add_f32 v[26:27], v[28:29], v[20:21] op_sel:[0,1] op_sel_hi:[1,0] neg_lo:[0,1]
  v_pk_add_f32 v[32:33], v[34:35], v[38:39] op_sel:[0,1] op_sel_hi:[1,0] neg_hi:[0,1]
  v_pk_add_f32 v[28:29], v[34:35], v[38:39] op_sel:[0,1] op_sel_hi:[1,0] neg_lo:[0,1]
  v_pk_add_f32 v[36:37], v[30:31], v[30:31] op_sel:[0,1] op_sel_hi:[1,0] neg_hi:[0,1]
  v_pk_add_f32 v[20:21], v[22:23], v[22:23] op_sel:[0,1] op_sel_hi:[1,0] neg_lo:[0,1]
  v_pk_add_f32 v[34:35], v[36:37], v[20:21] neg_lo:[0,1] neg_hi:[0,1]
  v_pk_add_f32 v[30:31], v[36:37], v[20:21]
  v_pk_fma_f32 v[38:39], v[34:35], s[60:61], v[32:33]
  v_pk_fma_f32 v[22:23], v[34:35], s[60:61], v[32:33] neg_lo:[1,0,0] neg_hi:[1,0,0]
  v_pk_fma_f32 v[36:37], v[30:31], s[60:61], v[28:29] op_sel:[1,0,0] op_sel_hi:[0,1,1] neg_hi:[1,0,0]
  v_pk_fma_f32 v[20:21], v[30:31], s[60:61], v[28:29] op_sel:[1,0,0] op_sel_hi:[0,1,1] neg_lo:[1,0,0]
  v_pk_mul_f32 v[32:33], v[38:39], v[94:95] op_sel:[0,0] op_sel_hi:[1,0]
  v_pk_fma_f32 v[38:39], v[38:39], v[94:95], v[32:33] op_sel:[1,1,0] op_sel_hi:[0,1,1] neg_lo:[0,1,0]
  v_pk_mul_f32 v[32:33], v[24:25], v[96:97] op_sel:[0,0] op_sel_hi:[1,0]
  v_pk_fma_f32 v[24:25], v[24:25], v[96:97], v[32:33] op_sel:[1,1,0] op_sel_hi:[0,1,1] neg_lo:[0,1,0]
  v_pk_mul_f32 v[32:33], v[36:37], v[98:99] op_sel:[0,0] op_sel_hi:[1,0]
  v_pk_fma_f32 v[36:37], v[36:37], v[98:99], v[32:33] op_sel:[1,1,0] op_sel_hi:[0,1,1] neg_lo:[0,1,0]
  v_pk_mul_f32 v[32:33], v[18:19], v[100:101] op_sel:[0,0] op_sel_hi:[1,0]
  v_pk_fma_f32 v[18:19], v[18:19], v[100:101], v[32:33] op_sel:[1,1,0] op_sel_hi:[0,1,1] neg_lo:[0,1,0]
  v_pk_mul_f32 v[32:33], v[22:23], v[102:103] op_sel:[0,0] op_sel_hi:[1,0]
  v_pk_fma_f32 v[22:23], v[22:23], v[102:103], v[32:33] op_sel:[1,1,0] op_sel_hi:[0,1,1] neg_lo:[0,1,0]
  v_pk_mul_f32 v[32:33], v[26:27], v[104:105] op_sel:[0,0] op_sel_hi:[1,0]
  v_pk_fma_f32 v[26:27], v[26:27], v[104:105], v[32:33] op_sel:[1,1,0] op_sel_hi:[0,1,1] neg_lo:[0,1,0]
  v_pk_mul_f32 v[32:33], v[20:21], v[106:107] op_sel:[0,0] op_sel_hi:[1,0]
  v_pk_fma_f32 v[20:21], v[20:21], v[106:107], v[32:33] op_sel:[1,1,0] op_sel_hi:[0,1,1] neg_lo:[0,1,0]
  ds_write_b64 v13, v[16:17] offset:0
  ds_write_b64 v13, v[38:39] offset:256
  ds_write_b64 v13, v[24:25] offset:512
  ds_write_b64 v13, v[36:37] offset:768
  ds_write_b64 v13, v[18:19] offset:1024
  ds_write_b64 v13, v[22:23] offset:1280
  ds_write_b64 v13, v[26:27] offset:1536
  ds_write_b64 v13, v[20:21] offset:1792
  s_waitcnt lgkmcnt(0)
  s_barrier
  v_and_b32 v14, 7, v0
  v_mul_u32_u24 v15, 2064, v14
  v_add_u32 v15, 18432, v15
  v_sub_u32 v9, 64, v8
  v_cmp_eq_u32 vcc, 0, v8
  v_mov_b32 v10, 32
  s_nop 1
  v_cndmask_b32 v9, v9, v10, vcc
  v_lshl_add_u32 v10, v8, 5, v15
  v_lshl_add_u32 v11, v9, 5, v15
  ds_read_b128 v[16:19], v10
  ds_read_b128 v[20:23], v10 offset:16
  ds_read_b128 v[24:27], v11
  ds_read_b128 v[28:31], v11 offset:16
  s_lshl_b32 s3, s2, 6
  v_lshl_add_u32 v12, v14, 3, s3
  v_lshl_add_u32 v13, v8, 14, v12
  v_lshl_add_u32 v14, v9, 14, v12
  s_mov_b32 s40, 0x0
  s_mov_b32 s41, 0x100000
  s_mov_b32 s42, 0x200000
  s_mov_b32 s43, 0x300000
  s_waitcnt lgkmcnt(0)
  v_pk_add_f32 v[32:33], v[16:17], v[20:21]
  v_pk_add_f32 v[20:21], v[16:17], v[20:21] neg_lo:[0,1] neg_hi:[0,1]
  v_pk_add_f32 v[34:35], v[18:19], v[22:23]
  v_pk_add_f32 v[22:23], v[18:19], v[22:23] neg_lo:[0,1] neg_hi:[0,1]
  v_pk_add_f32 v[16:17], v[32:33], v[34:35]
  v_pk_add_f32 v[18:19], v[32:33], v[34:35] neg_lo:[0,1] neg_hi:[0,1]
  v_pk_add_f32 v[32:33], v[20:21], v[22:23] op_sel:[0,1] op_sel_hi:[1,0] neg_hi:[0,1]
  v_pk_add_f32 v[34:35], v[20:21], v[22:23] op_sel:[0,1] op_sel_hi:[1,0] neg_lo:[0,1]
  v_pk_add_f32 v[36:37], v[24:25], v[28:29]
  v_pk_add_f32 v[28:29], v[24:25], v[28:29] neg_lo:[0,1] neg_hi:[0,1]
  v_pk_add_f32 v[38:39], v[26:27], v[30:31]
  v_pk_add_f32 v[30:31], v[26:27], v[30:31] neg_lo:[0,1] neg_hi:[0,1]
  v_pk_add_f32 v[24:25], v[36:37], v[38:39]
  v_pk_add_f32 v[26:27], v[36:37], v[38:39] neg_lo:[0,1] neg_hi:[0,1]
  v_pk_add_f32 v[36:37], v[28:29], v[30:31] op_sel:[0,1] op_sel_hi:[1,0] neg_hi:[0,1]
  v_pk_add_f32 v[38:39], v[28:29], v[30:31] op_sel:[0,1] op_sel_hi:[1,0] neg_lo:[0,1]
  s_mov_b64 s[50:51], exec
  s_andn2_b64 exec, exec, vcc
  v_pk_add_f32 v[40:41], v[16:17], v[38:39] neg_hi:[0,1]
  v_pk_add_f32 v[42:43], v[16:17], v[38:39] neg_lo:[0,1]
  v_pk_mul_f32 v[44:45], v[42:43], v[108:109] op_sel:[1,0] op_sel_hi:[0,0] neg_hi:[1,0]
  v_pk_fma_f32 v[44:45], v[42:43], v[108:109], v[44:45] op_sel:[0,1,0] op_sel_hi:[1,1,1]
  v_pk_add_f32 v[46:47], v[40:41], v[44:45]
  v_pk_add_f32 v[48:49], v[40:41], v[44:45] neg_lo:[0,1] neg_hi:[1,0]
  buffer_store_dwordx2 v[46:47], v13, s[16:19], s40 offen sc1
  buffer_store_dwordx2 v[48:49], v14, s[16:19], s43 offen sc1
  v_pk_add_f32 v[40:41], v[32:33], v[26:27] neg_hi:[0,1]
  v_pk_add_f32 v[42:43], v[32:33], v[26:27] neg_lo:[0,1]
  v_pk_mul_f32 v[44:45], v[42:43], v[110:111] op_sel:[1,0] op_sel_hi:[0,0] neg_hi:[1,0]
  v_pk_fma_f32 v[44:45], v[42:43], v[110:111], v[44:45] op_sel:[0,1,0] op_sel_hi:[1,1,1]
  v_pk_add_f32 v[50:51], v[40:41], v[44:45]
  v_pk_add_f32 v[52:53], v[40:41], v[44:45] neg_lo:[0,1] neg_hi:[1,0]
  buffer_store_dwordx2 v[50:51], v13, s[16:19], s41 offen sc1
  buffer_store_dwordx2 v[52:53], v14, s[16:19], s42 offen sc1
  v_pk_add_f32 v[40:41], v[18:19], v[36:37] neg_hi:[0,1]
  v_pk_add_f32 v[42:43], v[18:19], v[36:37] neg_lo:[0,1]
  v_pk_mul_f32 v[44:45], v[42:43], v[112:113] op_sel:[1,0] op_sel_hi:[0,0] neg_hi:[1,0]
  v_pk_fma_f32 v[44:45], v[42:43], v[112:113], v[44:45] op_sel:[0,1,0] op_sel_hi:[1,1,1]
  v_pk_add_f32 v[54:55], v[40:41], v[44:45]
  v_pk_add_f32 v[56:57], v[40:41], v[44:45] neg_lo:[0,1] neg_hi:[1,0]
  buffer_store_dwordx2 v[54:55], v13, s[16:19], s42 offen sc1
  buffer_store_dwordx2 v[56:57], v14, s[16:19], s41 offen sc1
  v_pk_add_f32 v[40:41], v[34:35], v[24:25] neg_hi:[0,1]
  v_pk_add_f32 v[42:43], v[34:35], v[24:25] neg_lo:[0,1]
  v_pk_mul_f32 v[44:45], v[42:43], v[114:115] op_sel:[1,0] op_sel_hi:[0,0] neg_hi:[1,0]
  v_pk_fma_f32 v[44:45], v[42:43], v[114:115], v[44:45] op_sel:[0,1,0] op_sel_hi:[1,1,1]
  v_pk_add_f32 v[58:59], v[40:41], v[44:45]
  v_pk_add_f32 v[60:61], v[40:41], v[44:45] neg_lo:[0,1] neg_hi:[1,0]
  buffer_store_dwordx2 v[58:59], v13, s[16:19], s43 offen sc1
  buffer_store_dwordx2 v[60:61], v14, s[16:19], s40 offen sc1
  s_and_b64 exec, s[50:51], vcc
  s_cbranch_execz l1_nospecial
  s_mov_b32 s52, 0x3f800000
  s_mov_b32 s53, 0x80000000
  v_pk_add_f32 v[40:41], v[16:17], v[16:17] neg_hi:[0,1]
  v_pk_add_f32 v[42:43], v[16:17], v[16:17] neg_lo:[0,1]
  v_pk_mul_f32 v[44:45], v[42:43], s[52:53] op_sel:[1,0] op_sel_hi:[0,0] neg_hi:[1,0]
  v_pk_fma_f32 v[44:45], v[42:43], s[52:53], v[44:45] op_sel:[0,1,0] op_sel_hi:[1,1,1]
  v_pk_add_f32 v[64:65], v[40:41], v[44:45]
  v_pk_add_f32 v[66:67], v[40:41], v[44:45] neg_lo:[0,1] neg_hi:[1,0]
  v_mov_b32 v65, v66
  buffer_store_dwordx2 v[64:65], v12, s[16:19], 0 offen sc1
  s_mov_b32 s52, 0x3f3504f3
  s_mov_b32 s53, 0xbf3504f3
  v_pk_add_f32 v[40:41], v[32:33], v[34:35] neg_hi:[0,1]
  v_pk_add_f32 v[42:43], v[32:33], v[34:35] neg_lo:[0,1]
  v_pk_mul_f32 v[44:45], v[42:43], s[52:53] op_sel:[1,0] op_sel_hi:[0,0] neg_hi:[1,0]
  v_pk_fma_f32 v[44:45], v[42:43], s[52:53], v[44:45] op_sel:[0,1,0] op_sel_hi:[1,1,1]
  v_pk_add_f32 v[68:69], v[40:41], v[44:45]
  v_pk_add_f32 v[70:71], v[40:41], v[44:45] neg_lo:[0,1] neg_hi:[1,0]
  s_mov_b32 s54, 0x100000
  buffer_store_dwordx2 v[68:69], v12, s[16:19], s54 offen sc1
  s_mov_b32 s54, 0x300000
  buffer_store_dwordx2 v[70:71], v12, s[16:19], s54 offen sc1
  s_mov_b32 s52, 0x248d3132
  s_mov_b32 s53, 0xbf800000
  v_pk_add_f32 v[40:41], v[18:19], v[18:19] neg_hi:[0,1]
  v_pk_add_f32 v[42:43], v[18:19], v[18:19] neg_lo:[0,1]
  v_pk_mul_f32 v[44:45], v[42:43], s[52:53] op_sel:[1,0] op_sel_hi:[0,0] neg_hi:[1,0]
  v_pk_fma_f32 v[44:45], v[42:43], s[52:53], v[44:45] op_sel:[0,1,0] op_sel_hi:[1,1,1]
  v_pk_add_f32 v[72:73], v[40:41], v[44:45]
  v_pk_add_f32 v[74:75], v[40:41], v[44:45] neg_lo:[0,1] neg_hi:[1,0]
  s_mov_b32 s54, 0x200000
  buffer_store_dwordx2 v[72:73], v12, s[16:19], s54 offen sc1
  s_mov_b32 s52, 0x3f6c835e
  s_mov_b32 s53, 0xbec3ef15
  v_pk_add_f32 v[40:41], v[24:25], v[38:39] neg_hi:[0,1]
  v_pk_add_f32 v[42:43], v[24:25], v[38:39] neg_lo:[0,1]
  v_pk_mul_f32 v[44:45], v[42:43], s[52:53] op_sel:[1,0] op_sel_hi:[0,0] neg_hi:[1,0]
  v_pk_fma_f32 v[44:45], v[42:43], s[52:53], v[44:45] op_sel:[0,1,0] op_sel_hi:[1,1,1]
  v_pk_add_f32 v[76:77], v[40:41], v[44:45]
  v_pk_add_f32 v[78:79], v[40:41], v[44:45] neg_lo:[0,1] neg_hi:[1,0]
  s_mov_b32 s54, 0x80000
  buffer_store_dwordx2 v[76:77], v12, s[16:19], s54 offen sc1
  s_mov_b32 s54, 0x380000
  buffer_store_dwordx2 v[78:79], v12, s[16:19], s54 offen sc1
  s_mov_b32 s52, 0x3ec3ef15
  s_mov_b32 s53, 0xbf6c835e
  v_pk_add_f32 v[40:41], v[36:37], v[26:27] neg_hi:[0,1]
  v_pk_add_f32 v[42:43], v[36:37], v[26:27] neg_lo:[0,1]
  v_pk_mul_f32 v[44:45], v[42:43], s[52:53] op_sel:[1,0] op_sel_hi:[0,0] neg_hi:[1,0]
  v_pk_fma_f32 v[44:45], v[42:43], s[52:53], v[44:45] op_sel:[0,1,0] op_sel_hi:[1,1,1]
  v_pk_add_f32 v[80:81], v[40:41], v[44:45]
  v_pk_add_f32 v[82:83], v[40:41], v[44:45] neg_lo:[0,1] neg_hi:[1,0]
  s_mov_b32 s54, 0x180000
  buffer_store_dwordx2 v[80:81], v12, s[16:19], s54 offen sc1
  s_mov_b32 s54, 0x280000
  buffer_store_dwordx2 v[82:83], v12, s[16:19], s54 offen sc1
l1_nospecial:
  s_mov_b64 exec, s[50:51]
  s_waitcnt vmcnt(0) lgkmcnt(0)
  s_barrier
  s_cmp_lg_u32 s95, 0
  s_cbranch_scc1 arr_skip_b
  s_mov_b64 s[92:93], exec
  s_mov_b64 exec, 1
  s_lshl_b32 s94, s2, 6
  v_mov_b32 v255, s94
  v_mov_b32 v254, 2
  buffer_store_dword v254, v255, s[76:79], 0 offen sc1
  s_mov_b64 exec, s[92:93]
arr_skip_b:
  s_mov_b32 s60, 0x3f3504f3
  s_mov_b32 s61, 0x3f3504f3
  s_lshl_b32 s3, s2, 14
  v_lshl_add_u32 v1, v0, 3, s3
  s_lshl_b32 s3, s2, 13
  v_lshl_add_u32 v2, v0, 2, s3
  s_add_u32 s8, s4, 0x590000
  s_addc_u32 s9, s5, 0
  s_mov_b32 s10, 0x400000
  s_mov_b32 s11, 0x00020000
  s_add_u32 s12, s4, 0x10000
  s_addc_u32 s13, s5, 0
  s_mov_b32 s14, 0x200000
  s_mov_b32 s15, 0x00020000
  s_add_u32 s20, s4, 0x990000
  s_addc_u32 s21, s5, 0
  s_mov_b32 s22, 0x400000
  s_mov_b32 s23, 0x00020000
  s_add_u32 s24, s4, 0x4000
  s_addc_u32 s25, s5, 0
  s_mov_b32 s26, 0x8000
  s_mov_b32 s27, 0x00020000
  s_movk_i32 s17, 4096
  v_cvt_f32_u32 v5, v0
  v_mul_f32 v5, 0x3a000000, v5
  v_cos_f32 v48, v5
  v_sin_f32 v49, -v5
  v_mul_f32 v6, 2.0, v5
  v_cos_f32 v50, v6
  v_sin_f32 v51, -v6
  v_mul_f32 v6, 0x40400000, v5
  v_cos_f32 v52, v6
  v_sin_f32 v53, -v6
  v_mul_f32 v6, 4.0, v5
  v_cos_f32 v54, v6
  v_sin_f32 v55, -v6
  v_mul_f32 v6, 0x40a00000, v5
  v_cos_f32 v56, v6
  v_sin_f32 v57, -v6
  v_mul_f32 v6, 0x40c00000, v5
  v_cos_f32 v58, v6
  v_sin_f32 v59, -v6
  v_mul_f32 v6, 0x40e00000, v5
  v_cos_f32 v60, v6
  v_sin_f32 v61, -v6
  v_and_b32 v7, 31, v0
  v_cvt_f32_u32 v5, v7
  v_mul_f32 v5, 0x3b800000, v5
  v_cos_f32 v62, v5
  v_sin_f32 v63, -v5
  v_mul_f32 v6, 2.0, v5
  v_cos_f32 v64, v6
  v_sin_f32 v65, -v6
  v_mul_f32 v6, 0x40400000, v5
  v_cos_f32 v66, v6
  v_sin_f32 v67, -v6
  v_mul_f32 v6, 4.0, v5
  v_cos_f32 v68, v6
  v_sin_f32 v69, -v6
  v_mul_f32 v6, 0x40a00000, v5
  v_cos_f32 v70, v6
  v_sin_f32 v71, -v6
  v_mul_f32 v6, 0x40c00000, v5
  v_cos_f32 v72, v6
  v_sin_f32 v73, -v6
  v_mul_f32 v6, 0x40e00000, v5
  v_cos_f32 v74, v6
  v_sin_f32 v75, -v6
  v_and_b32 v8, 3, v0
  v_cvt_f32_u32 v5, v8
  v_mul_f32 v5, 0x3d000000, v5
  v_cos_f32 v76, v5
  v_sin_f32 v77, -v5
  v_mul_f32 v6, 2.0, v5
  v_cos_f32 v78, v6
  v_sin_f32 v79, -v6
  v_mul_f32 v6, 0x40400000, v5
  v_cos_f32 v80, v6
  v_sin_f32 v81, -v6
  v_mul_f32 v6, 4.0, v5
  v_cos_f32 v82, v6
  v_sin_f32 v83, -v6
  v_mul_f32 v6, 0x40a00000, v5
  v_cos_f32 v84, v6
  v_sin_f32 v85, -v6
  v_mul_f32 v6, 0x40c00000, v5
  v_cos_f32 v86, v6
  v_sin_f32 v87, -v6
  v_mul_f32 v6, 0x40e00000, v5
  v_cos_f32 v88, v6
  v_sin_f32 v89, -v6
  v_lshlrev_b32 v9, 3, v0
  v_lshrrev_b32 v10, 5, v0
  v_lshlrev_b32 v11, 11, v10
  v_lshl_add_u32 v11, v7, 3, v11
  v_mul_u32_u24 v12, 2304, v10
  v_add_u32 v12, 16384, v12
  v_lshl_add_u32 v13, v7, 3, v12
  v_bfe_u32 v14, v0, 2, 3
  v_mul_u32_u24 v14, 288, v14
  v_add_u32 v14, v14, v12
  v_lshl_add_u32 v15, v8, 6, v14
  v_lshl_add_u32 v14, v8, 3, v14
  s_cmp_lg_u32 s95, 0
  s_cbranch_scc1 wait_skip_b
  v_and_b32 v253, 63, v0
  v_lshlrev_b32 v253, 6, v253
  s_mov_b64 s[92:93], exec
  s_mov_b64 exec, 15
wait_loop0_b:
  buffer_load_dword v254, v253, s[96:99], 0 offen sc1
  s_waitcnt vmcnt(0)
  v_cmp_gt_u32 vcc, 64, v254
  s_cmp_eq_u64 vcc, 0
  s_cbranch_scc0 wait_loop0_b
  s_mov_b64 exec, s[92:93]
wait_loop_b:
  s_movk_i32 s94, 0
  buffer_load_dword v249, v253, s[76:79], s94 offen sc1
  s_movk_i32 s94, 4096
  buffer_load_dword v250, v253, s[76:79], s94 offen sc1
  s_movk_i32 s94, 8192
  buffer_load_dword v251, v253, s[76:79], s94 offen sc1
  s_movk_i32 s94, 12288
  buffer_load_dword v252, v253, s[76:79], s94 offen sc1
  s_waitcnt vmcnt(0)
  v_min_u32 v249, v249, v250
  v_min_u32 v251, v251, v252
  v_min_u32 v249, v249, v251
  v_cmp_gt_u32 vcc, 2, v249
  s_cmp_eq_u64 vcc, 0
  s_cbranch_scc1 wait_skip_b
  s_sleep 3
  s_branch wait_loop_b
wait_skip_b:
  s_barrier
  s_cmp_lg_u32 s95, 0
  s_cbranch_scc1 rr_skip
  v_and_b32 v253, 7, v0
  v_and_b32 v254, 3, v253
  v_lshlrev_b32 v254, 6, v254
  v_lshrrev_b32 v253, 2, v253
  v_lshl_add_u32 v254, v253, 2, v254
  buffer_load_dword v253, v254, s[96:99], 0 offen offset:8 sc1
  s_waitcnt vmcnt(0)
  v_cmp_ne_u32 vcc, 32, v253
  v_readfirstlane_b32 s3, v239
  s_lshl_b32 s94, s68, 5
  s_add_u32 s94, s94, s3
  s_cmp_eq_u64 vcc, 0
  s_cselect_b32 s3, 1, 0
  s_cmp_eq_u32 s3, 1
  s_cselect_b32 s94, s94, s2
  v_mov_b32 v254, s94
  v_mov_b32 v255, s3
  v_mov_b32 v252, 151552
  ds_write_b64 v252, v[254:255]
rr_skip:
  buffer_load_dwordx2 v[16:17], v1, s[8:11], 0 offen offset:0
  buffer_load_dwordx2 v[18:19], v1, s[8:11], 0 offen offset:2048
  s_movk_i32 s19, 4096
  buffer_load_dwordx2 v[20:21], v1, s[8:11], s19 offen
  s_movk_i32 s19, 6144
  buffer_load_dwordx2 v[22:23], v1, s[8:11], s19 offen
  s_movk_i32 s19, 8192
  buffer_load_dwordx2 v[24:25], v1, s[8:11], s19 offen
  s_movk_i32 s19, 10240
  buffer_load_dwordx2 v[26:27], v1, s[8:11], s19 offen
  s_movk_i32 s19, 12288
  buffer_load_dwordx2 v[28:29], v1, s[8:11], s19 offen
  s_movk_i32 s19, 14336
  buffer_load_dwordx2 v[30:31], v1, s[8:11], s19 offen
  buffer_load_dword v40, v2, s[12:15], 0 offen offset:0
  buffer_load_dword v41, v2, s[12:15], 0 offen offset:1024
  buffer_load_dword v42, v2, s[12:15], 0 offen offset:2048
  buffer_load_dword v43, v2, s[12:15], 0 offen offset:3072
  buffer_load_dword v44, v2, s[12:15], s17 offen offset:0
  buffer_load_dword v45, v2, s[12:15], s17 offen offset:1024
  buffer_load_dword v46, v2, s[12:15], s17 offen offset:2048
  buffer_load_dword v47, v2, s[12:15], s17 offen offset:3072
  s_cmp_lg_u32 s2, 0
  s_cbranch_scc1 l2_nowab
  v_lshlrev_b32 v3, 4, v0
  s_movk_i32 s19, 0
  buffer_load_dwordx4 v[128:131], v3, s[24:27], s19 offen
  s_movk_i32 s19, 4096
  buffer_load_dwordx4 v[132:135], v3, s[24:27], s19 offen
  s_movk_i32 s19, 8192
  buffer_load_dwordx4 v[136:139], v3, s[24:27], s19 offen
  s_movk_i32 s19, 12288
  buffer_load_dwordx4 v[140:143], v3, s[24:27], s19 offen
  s_movk_i32 s19, 16384
  buffer_load_dwordx4 v[144:147], v3, s[24:27], s19 offen
  s_movk_i32 s19, 20480
  buffer_load_dwordx4 v[148:151], v3, s[24:27], s19 offen
  s_movk_i32 s19, 24576
  buffer_load_dwordx4 v[152:155], v3, s[24:27], s19 offen
  s_movk_i32 s19, 28672
  buffer_load_dwordx4 v[156:159], v3, s[24:27], s19 offen
  s_waitcnt vmcnt(16)
  s_branch l2_go
l2_nowab:
  s_waitcnt vmcnt(8)
l2_go:
  v_pk_add_f32 v[32:33], v[16:17], v[24:25]
  v_pk_add_f32 v[24:25], v[16:17], v[24:25] neg_lo:[0,1] neg_hi:[0,1]
  v_pk_add_f32 v[34:35], v[18:19], v[26:27]
  v_pk_add_f32 v[26:27], v[18:19], v[26:27] neg_lo:[0,1] neg_hi:[0,1]
  v_pk_add_f32 v[36:37], v[20:21], v[28:29]
  v_pk_add_f32 v[28:29], v[20:21], v[28:29] neg_lo:[0,1] neg_hi:[0,1]
  v_pk_add_f32 v[38:39], v[22:23], v[30:31]
  v_pk_add_f32 v[30:31], v[22:23], v[30:31] neg_lo:[0,1] neg_hi:[0,1]
  v_pk_add_f32 v[16:17], v[32:33], v[36:37]
  v_pk_add_f32 v[18:19], v[32:33], v[36:37] neg_lo:[0,1] neg_hi:[0,1]
  v_pk_add_f32 v[20:21], v[34:35], v[38:39]
  v_pk_add_f32 v[22:23], v[34:35], v[38:39] neg_lo:[0,1] neg_hi:[0,1]
  v_pk_add_f32 v[32:33], v[16:17], v[20:21]
  v_pk_add_f32 v[34:35], v[16:17], v[20:21] neg_lo:[0,1] neg_hi:[0,1]
  v_pk_add_f32 v[36:37], v[18:19], v[22:23] op_sel:[0,1] op_sel_hi:[1,0] neg_hi:[0,1]
  v_pk_add_f32 v[38:39], v[18:19], v[22:23] op_sel:[0,1] op_sel_hi:[1,0] neg_lo:[0,1]
  v_pk_add_f32 v[16:17], v[24:25], v[28:29] op_sel:[0,1] op_sel_hi:[1,0] neg_hi:[0,1]
  v_pk_add_f32 v[18:19], v[24:25], v[28:29] op_sel:[0,1] op_sel_hi:[1,0] neg_lo:[0,1]
  v_pk_add_f32 v[20:21], v[26:27], v[26:27] op_sel:[0,1] op_sel_hi:[1,0] neg_hi:[0,1]
  v_pk_add_f32 v[22:23], v[30:31], v[30:31] op_sel:[0,1] op_sel_hi:[1,0] neg_lo:[0,1]
  v_pk_add_f32 v[24:25], v[20:21], v[22:23] neg_lo:[0,1] neg_hi:[0,1]
  v_pk_add_f32 v[26:27], v[20:21], v[22:23]
  v_pk_fma_f32 v[28:29], v[24:25], s[60:61], v[16:17]
  v_pk_fma_f32 v[30:31], v[24:25], s[60:61], v[16:17] neg_lo:[1,0,0] neg_hi:[1,0,0]
  v_pk_fma_f32 v[20:21], v[26:27], s[60:61], v[18:19] op_sel:[1,0,0] op_sel_hi:[0,1,1] neg_hi:[1,0,0]
  v_pk_fma_f32 v[22:23], v[26:27], s[60:61], v[18:19] op_sel:[1,0,0] op_sel_hi:[0,1,1] neg_lo:[1,0,0]
  v_pk_mul_f32 v[16:17], v[28:29], v[48:49] op_sel:[0,0] op_sel_hi:[1,0]
  v_pk_fma_f32 v[28:29], v[28:29], v[48:49], v[16:17] op_sel:[1,1,0] op_sel_hi:[0,1,1] neg_lo:[0,1,0]
  v_pk_mul_f32 v[16:17], v[36:37], v[50:51] op_sel:[0,0] op_sel_hi:[1,0]
  v_pk_fma_f32 v[36:37], v[36:37], v[50:51], v[16:17] op_sel:[1,1,0] op_sel_hi:[0,1,1] neg_lo:[0,1,0]
  v_pk_mul_f32 v[16:17], v[20:21], v[52:53] op_sel:[0,0] op_sel_hi:[1,0]
  v_pk_fma_f32 v[20:21], v[20:21], v[52:53], v[16:17] op_sel:[1,1,0] op_sel_hi:[0,1,1] neg_lo:[0,1,0]
  v_pk_mul_f32 v[16:17], v[34:35], v[54:55] op_sel:[0,0] op_sel_hi:[1,0]
  v_pk_fma_f32 v[34:35], v[34:35], v[54:55], v[16:17] op_sel:[1,1,0] op_sel_hi:[0,1,1] neg_lo:[0,1,0]
  v_pk_mul_f32 v[16:17], v[30:31], v[56:57] op_sel:[0,0] op_sel_hi:[1,0]
  v_pk_fma_f32 v[30:31], v[30:31], v[56:57], v[16:17] op_sel:[1,1,0] op_sel_hi:[0,1,1] neg_lo:[0,1,0]
  v_pk_mul_f32 v[16:17], v[38:39], v[58:59] op_sel:[0,0] op_sel_hi:[1,0]
  v_pk_fma_f32 v[38:39], v[38:39], v[58:59], v[16:17] op_sel:[1,1,0] op_sel_hi:[0,1,1] neg_lo:[0,1,0]
  v_pk_mul_f32 v[16:17], v[22:23], v[60:61] op_sel:[0,0] op_sel_hi:[1,0]
  v_pk_fma_f32 v[22:23], v[22:23], v[60:61], v[16:17] op_sel:[1,1,0] op_sel_hi:[0,1,1] neg_lo:[0,1,0]
  ds_write_b64 v9, v[32:33] offset:0
  ds_write_b64 v9, v[28:29] offset:2048
  ds_write_b64 v9, v[36:37] offset:4096
  ds_write_b64 v9, v[20:21] offset:6144
  ds_write_b64 v9, v[34:35] offset:8192
  ds_write_b64 v9, v[30:31] offset:10240
  ds_write_b64 v9, v[38:39] offset:12288
  ds_write_b64 v9, v[22:23] offset:14336
  s_waitcnt lgkmcnt(0)
  s_barrier
  ds_read_b64 v[32:33], v11 offset:0
  ds_read_b64 v[28:29], v11 offset:256
  ds_read_b64 v[36:37], v11 offset:512
  ds_read_b64 v[20:21], v11 offset:768
  ds_read_b64 v[34:35], v11 offset:1024
  ds_read_b64 v[30:31], v11 offset:1280
  ds_read_b64 v[38:39], v11 offset:1536
  ds_read_b64 v[22:23], v11 offset:1792
  s_waitcnt lgkmcnt(0)
  v_pk_add_f32 v[16:17], v[32:33], v[34:35]
  v_pk_add_f32 v[34:35], v[32:33], v[34:35] neg_lo:[0,1] neg_hi:[0,1]
  v_pk_add_f32 v[18:19], v[28:29], v[30:31]
  v_pk_add_f32 v[30:31], v[28:29], v[30:31] neg_lo:[0,1] neg_hi:[0,1]
  v_pk_add_f32 v[24:25], v[36:37], v[38:39]
  v_pk_add_f32 v[38:39], v[36:37], v[38:39] neg_lo:[0,1] neg_hi:[0,1]
  v_pk_add_f32 v[26:27], v[20:21], v[22:23]
  v_pk_add_f32 v[22:23], v[20:21], v[22:23] neg_lo:[0,1] neg_hi:[0,1]
  v_pk_add_f32 v[32:33], v[16:17], v[24:25]
  v_pk_add_f32 v[28:29], v[16:17], v[24:25] neg_lo:[0,1] neg_hi:[0,1]
  v_pk_add_f32 v[36:37], v[18:19], v[26:27]
  v_pk_add_f32 v[20:21], v[18:19], v[26:27] neg_lo:[0,1] neg_hi:[0,1]
  v_pk_add_f32 v[16:17], v[32:33], v[36:37]
  v_pk_add_f32 v[18:19], v[32:33], v[36:37] neg_lo:[0,1] neg_hi:[0,1]
  v_pk_add_f32 v[24:25], v[28:29], v[20:21] op_sel:[0,1] op_sel_hi:[1,0] neg_hi:[0,1]
  v_pk_add_f32 v[26:27], v[28:29], v[20:21] op_sel:[0,1] op_sel_hi:[1,0] neg_lo:[0,1]
  v_pk_add_f32 v[32:33], v[34:35], v[38:39] op_sel:[0,1] op_sel_hi:[1,0] neg_hi:[0,1]
  v_pk_add_f32 v[28:29], v[34:35], v[38:39] op_sel:[0,1] op_sel_hi:[1,0] neg_lo:[0,1]
  v_pk_add_f32 v[36:37], v[30:31], v[30:31] op_sel:[0,1] op_sel_hi:[1,0] neg_hi:[0,1]
  v_pk_add_f32 v[20:21], v[22:23], v[22:23] op_sel:[0,1] op_sel_hi:[1,0] neg_lo:[0,1]
  v_pk_add_f32 v[34:35], v[36:37], v[20:21] neg_lo:[0,1] neg_hi:[0,1]
  v_pk_add_f32 v[30:31], v[36:37], v[20:21]
  v_pk_fma_f32 v[38:39], v[34:35], s[60:61], v[32:33]
  v_pk_fma_f32 v[22:23], v[34:35], s[60:61], v[32:33] neg_lo:[1,0,0] neg_hi:[1,0,0]
  v_pk_fma_f32 v[36:37], v[30:31], s[60:61], v[28:29] op_sel:[1,0,0] op_sel_hi:[0,1,1] neg_hi:[1,0,0]
  v_pk_fma_f32 v[20:21], v[30:31], s[60:61], v[28:29] op_sel:[1,0,0] op_sel_hi:[0,1,1] neg_lo:[1,0,0]
  v_pk_mul_f32 v[32:33], v[38:39], v[62:63] op_sel:[0,0] op_sel_hi:[1,0]
  v_pk_fma_f32 v[38:39], v[38:39], v[62:63], v[32:33] op_sel:[1,1,0] op_sel_hi:[0,1,1] neg_lo:[0,1,0]
  v_pk_mul_f32 v[32:33], v[24:25], v[64:65] op_sel:[0,0] op_sel_hi:[1,0]
  v_pk_fma_f32 v[24:25], v[24:25], v[64:65], v[32:33] op_sel:[1,1,0] op_sel_hi:[0,1,1] neg_lo:[0,1,0]
  v_pk_mul_f32 v[32:33], v[36:37], v[66:67] op_sel:[0,0] op_sel_hi:[1,0]
  v_pk_fma_f32 v[36:37], v[36:37], v[66:67], v[32:33] op_sel:[1,1,0] op_sel_hi:[0,1,1] neg_lo:[0,1,0]
  v_pk_mul_f32 v[32:33], v[18:19], v[68:69] op_sel:[0,0] op_sel_hi:[1,0]
  v_pk_fma_f32 v[18:19], v[18:19], v[68:69], v[32:33] op_sel:[1,1,0] op_sel_hi:[0,1,1] neg_lo:[0,1,0]
  v_pk_mul_f32 v[32:33], v[22:23], v[70:71] op_sel:[0,0] op_sel_hi:[1,0]
  v_pk_fma_f32 v[22:23], v[22:23], v[70:71], v[32:33] op_sel:[1,1,0] op_sel_hi:[0,1,1] neg_lo:[0,1,0]
  v_pk_mul_f32 v[32:33], v[26:27], v[72:73] op_sel:[0,0] op_sel_hi:[1,0]
  v_pk_fma_f32 v[26:27], v[26:27], v[72:73], v[32:33] op_sel:[1,1,0] op_sel_hi:[0,1,1] neg_lo:[0,1,0]
  v_pk_mul_f32 v[32:33], v[20:21], v[74:75] op_sel:[0,0] op_sel_hi:[1,0]
  v_pk_fma_f32 v[20:21], v[20:21], v[74:75], v[32:33] op_sel:[1,1,0] op_sel_hi:[0,1,1] neg_lo:[0,1,0]
  ds_write_b64 v13, v[16:17] offset:0
  ds_write_b64 v13, v[38:39] offset:288
  ds_write_b64 v13, v[24:25] offset:576
  ds_write_b64 v13, v[36:37] offset:864
  ds_write_b64 v13, v[18:19] offset:1152
  ds_write_b64 v13, v[22:23] offset:1440
  ds_write_b64 v13, v[26:27] offset:1728
  ds_write_b64 v13, v[20:21] offset:2016
  ds_read_b64 v[16:17], v14 offset:0
  ds_read_b64 v[38:39], v14 offset:32
  ds_read_b64 v[24:25], v14 offset:64
  ds_read_b64 v[36:37], v14 offset:96
  ds_read_b64 v[18:19], v14 offset:128
  ds_read_b64 v[22:23], v14 offset:160
  ds_read_b64 v[26:27], v14 offset:192
  ds_read_b64 v[20:21], v14 offset:224
  s_waitcnt lgkmcnt(0)
  v_pk_add_f32 v[32:33], v[16:17], v[18:19]
  v_pk_add_f32 v[18:19], v[16:17], v[18:19] neg_lo:[0,1] neg_hi:[0,1]
  v_pk_add_f32 v[28:29], v[38:39], v[22:23]
  v_pk_add_f32 v[22:23], v[38:39], v[22:23] neg_lo:[0,1] neg_hi:[0,1]
  v_pk_add_f32 v[34:35], v[24:25], v[26:27]
  v_pk_add_f32 v[26:27], v[24:25], v[26:27] neg_lo:[0,1] neg_hi:[0,1]
  v_pk_add_f32 v[30:31], v[36:37], v[20:21]
  v_pk_add_f32 v[20:21], v[36:37], v[20:21] neg_lo:[0,1] neg_hi:[0,1]
  v_pk_add_f32 v[16:17], v[32:33], v[34:35]
  v_pk_add_f32 v[38:39], v[32:33], v[34:35] neg_lo:[0,1] neg_hi:[0,1]
  v_pk_add_f32 v[24:25], v[28:29], v[30:31]
  v_pk_add_f32 v[36:37], v[28:29], v[30:31] neg_lo:[0,1] neg_hi:[0,1]
  v_pk_add_f32 v[32:33], v[16:17], v[24:25]
  v_pk_add_f32 v[28:29], v[16:17], v[24:25] neg_lo:[0,1] neg_hi:[0,1]
  v_pk_add_f32 v[34:35], v[38:39], v[36:37] op_sel:[0,1] op_sel_hi:[1,0] neg_hi:[0,1]
  v_pk_add_f32 v[30:31], v[38:39], v[36:37] op_sel:[0,1] op_sel_hi:[1,0] neg_lo:[0,1]
  v_pk_add_f32 v[16:17], v[18:19], v[26:27] op_sel:[0,1] op_sel_hi:[1,0] neg_hi:[0,1]
  v_pk_add_f32 v[38:39], v[18:19], v[26:27] op_sel:[0,1] op_sel_hi:[1,0] neg_lo:[0,1]
  v_pk_add_f32 v[24:25], v[22:23], v[22:23] op_sel:[0,1] op_sel_hi:[1,0] neg_hi:[0,1]
  v_pk_add_f32 v[36:37], v[20:21], v[20:21] op_sel:[0,1] op_sel_hi:[1,0] neg_lo:[0,1]
  v_pk_add_f32 v[18:19], v[24:25], v[36:37] neg_lo:[0,1] neg_hi:[0,1]
  v_pk_add_f32 v[22:23], v[24:25], v[36:37]
  v_pk_fma_f32 v[26:27], v[18:19], s[60:61], v[16:17]
  v_pk_fma_f32 v[20:21], v[18:19], s[60:61], v[16:17] neg_lo:[1,0,0] neg_hi:[1,0,0]
  v_pk_fma_f32 v[24:25], v[22:23], s[60:61], v[38:39] op_sel:[1,0,0] op_sel_hi:[0,1,1] neg_hi:[1,0,0]
  v_pk_fma_f32 v[36:37], v[22:23], s[60:61], v[38:39] op_sel:[1,0,0] op_sel_hi:[0,1,1] neg_lo:[1,0,0]
  v_pk_mul_f32 v[16:17], v[26:27], v[76:77] op_sel:[0,0] op_sel_hi:[1,0]
  v_pk_fma_f32 v[26:27], v[26:27], v[76:77], v[16:17] op_sel:[1,1,0] op_sel_hi:[0,1,1] neg_lo:[0,1,0]
  v_pk_mul_f32 v[16:17], v[34:35], v[78:79] op_sel:[0,0] op_sel_hi:[1,0]
  v_pk_fma_f32 v[34:35], v[34:35], v[78:79], v[16:17] op_sel:[1,1,0] op_sel_hi:[0,1,1] neg_lo:[0,1,0]
  v_pk_mul_f32 v[16:17], v[24:25], v[80:81] op_sel:[0,0] op_sel_hi:[1,0]
  v_pk_fma_f32 v[24:25], v[24:25], v[80:81], v[16:17] op_sel:[1,1,0] op_sel_hi:[0,1,1] neg_lo:[0,1,0]
  v_pk_mul_f32 v[16:17], v[28:29], v[82:83] op_sel:[0,0] op_sel_hi:[1,0]
  v_pk_fma_f32 v[28:29], v[28:29], v[82:83], v[16:17] op_sel:[1,1,0] op_sel_hi:[0,1,1] neg_lo:[0,1,0]
  v_pk_mul_f32 v[16:17], v[20:21], v[84:85] op_sel:[0,0] op_sel_hi:[1,0]
  v_pk_fma_f32 v[20:21], v[20:21], v[84:85], v[16:17] op_sel:[1,1,0] op_sel_hi:[0,1,1] neg_lo:[0,1,0]
  v_pk_mul_f32 v[16:17], v[30:31], v[86:87] op_sel:[0,0] op_sel_hi:[1,0]
  v_pk_fma_f32 v[30:31], v[30:31], v[86:87], v[16:17] op_sel:[1,1,0] op_sel_hi:[0,1,1] neg_lo:[0,1,0]
  v_pk_mul_f32 v[16:17], v[36:37], v[88:89] op_sel:[0,0] op_sel_hi:[1,0]
  v_pk_fma_f32 v[36:37], v[36:37], v[88:89], v[16:17] op_sel:[1,1,0] op_sel_hi:[0,1,1] neg_lo:[0,1,0]
  ds_write_b64 v14, v[32:33] offset:0
  ds_write_b64 v14, v[26:27] offset:32
  ds_write_b64 v14, v[34:35] offset:64
  ds_write_b64 v14, v[24:25] offset:96
  ds_write_b64 v14, v[28:29] offset:128
  ds_write_b64 v14, v[20:21] offset:160
  ds_write_b64 v14, v[30:31] offset:192
  ds_write_b64 v14, v[36:37] offset:224
  s_waitcnt lgkmcnt(0)
  ds_read_b128 v[16:19], v15 offset:0
  ds_read_b128 v[20:23], v15 offset:16
  ds_read_b128 v[24:27], v15 offset:32
  ds_read_b128 v[28:31], v15 offset:48
  s_waitcnt lgkmcnt(0)
  v_pk_add_f32 v[32:33], v[16:17], v[20:21]
  v_pk_add_f32 v[20:21], v[16:17], v[20:21] neg_lo:[0,1] neg_hi:[0,1]
  v_pk_add_f32 v[34:35], v[18:19], v[22:23]
  v_pk_add_f32 v[22:23], v[18:19], v[22:23] neg_lo:[0,1] neg_hi:[0,1]
  v_pk_add_f32 v[16:17], v[32:33], v[34:35]
  v_pk_add_f32 v[18:19], v[32:33], v[34:35] neg_lo:[0,1] neg_hi:[0,1]
  v_pk_add_f32 v[32:33], v[20:21], v[22:23] op_sel:[0,1] op_sel_hi:[1,0] neg_hi:[0,1]
  v_pk_add_f32 v[34:35], v[20:21], v[22:23] op_sel:[0,1] op_sel_hi:[1,0] neg_lo:[0,1]
  v_pk_add_f32 v[36:37], v[24:25], v[28:29]
  v_pk_add_f32 v[28:29], v[24:25], v[28:29] neg_lo:[0,1] neg_hi:[0,1]
  v_pk_add_f32 v[38:39], v[26:27], v[30:31]
  v_pk_add_f32 v[30:31], v[26:27], v[30:31] neg_lo:[0,1] neg_hi:[0,1]
  v_pk_add_f32 v[24:25], v[36:37], v[38:39]
  v_pk_add_f32 v[26:27], v[36:37], v[38:39] neg_lo:[0,1] neg_hi:[0,1]
  v_pk_add_f32 v[36:37], v[28:29], v[30:31] op_sel:[0,1] op_sel_hi:[1,0] neg_hi:[0,1]
  v_pk_add_f32 v[38:39], v[28:29], v[30:31] op_sel:[0,1] op_sel_hi:[1,0] neg_lo:[0,1]
  s_waitcnt vmcnt(0)
  s_cmp_eq_u32 s2, 0
  s_cbranch_scc1 l2_col0
  v_lshlrev_b32 v90, 16, v40
  v_and_b32 v91, 0xffff0000, v40
  v_pk_mul_f32 v[92:93], v[16:17], v[90:91] op_sel:[0,0] op_sel_hi:[1,0]
  v_pk_fma_f32 v[16:17], v[16:17], v[90:91], v[92:93] op_sel:[1,1,0] op_sel_hi:[0,1,1] neg_lo:[0,1,0]
  v_lshlrev_b32 v90, 16, v41
  v_and_b32 v91, 0xffff0000, v41
  v_pk_mul_f32 v[92:93], v[24:25], v[90:91] op_sel:[0,0] op_sel_hi:[1,0]
  v_pk_fma_f32 v[24:25], v[24:25], v[90:91], v[92:93] op_sel:[1,1,0] op_sel_hi:[0,1,1] neg_lo:[0,1,0]
  v_lshlrev_b32 v90, 16, v42
  v_and_b32 v91, 0xffff0000, v42
  v_pk_mul_f32 v[92:93], v[32:33], v[90:91] op_sel:[0,0] op_sel_hi:[1,0]
  v_pk_fma_f32 v[32:33], v[32:33], v[90:91], v[92:93] op_sel:[1,1,0] op_sel_hi:[0,1,1] neg_lo:[0,1,0]
  v_lshlrev_b32 v90, 16, v43
  v_and_b32 v91, 0xffff0000, v43
  v_pk_mul_f32 v[92:93], v[36:37], v[90:91] op_sel:[0,0] op_sel_hi:[1,0]
  v_pk_fma_f32 v[36:37], v[36:37], v[90:91], v[92:93] op_sel:[1,1,0] op_sel_hi:[0,1,1] neg_lo:[0,1,0]
  v_lshlrev_b32 v90, 16, v44
  v_and_b32 v91, 0xffff0000, v44
  v_pk_mul_f32 v[92:93], v[18:19], v[90:91] op_sel:[0,0] op_sel_hi:[1,0]
  v_pk_fma_f32 v[18:19], v[18:19], v[90:91], v[92:93] op_sel:[1,1,0] op_sel_hi:[0,1,1] neg_lo:[0,1,0]
  v_lshlrev_b32 v90, 16, v45
  v_and_b32 v91, 0xffff0000, v45
  v_pk_mul_f32 v[92:93], v[26:27], v[90:91] op_sel:[0,0] op_sel_hi:[1,0]
  v_pk_fma_f32 v[26:27], v[26:27], v[90:91], v[92:93] op_sel:[1,1,0] op_sel_hi:[0,1,1] neg_lo:[0,1,0]
  v_lshlrev_b32 v90, 16, v46
  v_and_b32 v91, 0xffff0000, v46
  v_pk_mul_f32 v[92:93], v[34:35], v[90:91] op_sel:[0,0] op_sel_hi:[1,0]
  v_pk_fma_f32 v[34:35], v[34:35], v[90:91], v[92:93] op_sel:[1,1,0] op_sel_hi:[0,1,1] neg_lo:[0,1,0]
  v_lshlrev_b32 v90, 16, v47
  v_and_b32 v91, 0xffff0000, v47
  v_pk_mul_f32 v[92:93], v[38:39], v[90:91] op_sel:[0,0] op_sel_hi:[1,0]
  v_pk_fma_f32 v[38:39], v[38:39], v[90:91], v[92:93] op_sel:[1,1,0] op_sel_hi:[0,1,1] neg_lo:[0,1,0]
  s_branch l2_inv
l2_col0:
  v_lshrrev_b32 v3, 5, v0
  v_bfe_u32 v4, v0, 2, 3
  v_lshl_add_u32 v3, v4, 3, v3
  v_lshl_add_u32 v3, v8, 7, v3
  v_lshlrev_b32 v4, 3, v3
  v_add_u32 v4, 34816, v4
  ds_write_b64 v4, v[16:17] offset:0
  ds_write_b64 v4, v[24:25] offset:512
  ds_write_b64 v4, v[32:33] offset:4096
  ds_write_b64 v4, v[36:37] offset:4608
  ds_write_b64 v4, v[18:19] offset:8192
  ds_write_b64 v4, v[26:27] offset:8704
  ds_write_b64 v4, v[34:35] offset:12288
  ds_write_b64 v4, v[38:39] offset:12800
  s_waitcnt lgkmcnt(0)
  s_barrier
  v_add_u32 v5, 0, v3
  v_sub_u32 v5, 2048, v5
  v_and_b32 v5, 2047, v5
  v_lshlrev_b32 v5, 3, v5
  v_add_u32 v5, 34816, v5
  ds_read_b64 v[96:97], v5
  v_add_u32 v5, 64, v3
  v_sub_u32 v5, 2048, v5
  v_and_b32 v5, 2047, v5
  v_lshlrev_b32 v5, 3, v5
  v_add_u32 v5, 34816, v5
  ds_read_b64 v[98:99], v5
  v_add_u32 v5, 512, v3
  v_sub_u32 v5, 2048, v5
  v_and_b32 v5, 2047, v5
  v_lshlrev_b32 v5, 3, v5
  v_add_u32 v5, 34816, v5
  ds_read_b64 v[100:101], v5
  v_add_u32 v5, 576, v3
  v_sub_u32 v5, 2048, v5
  v_and_b32 v5, 2047, v5
  v_lshlrev_b32 v5, 3, v5
  v_add_u32 v5, 34816, v5
  ds_read_b64 v[102:103], v5
  v_add_u32 v5, 1024, v3
  v_sub_u32 v5, 2048, v5
  v_and_b32 v5, 2047, v5
  v_lshlrev_b32 v5, 3, v5
  v_add_u32 v5, 34816, v5
  ds_read_b64 v[104:105], v5
  v_add_u32 v5, 1088, v3
  v_sub_u32 v5, 2048, v5
  v_and_b32 v5, 2047, v5
  v_lshlrev_b32 v5, 3, v5
  v_add_u32 v5, 34816, v5
  ds_read_b64 v[106:107], v5
  v_add_u32 v5, 1536, v3
  v_sub_u32 v5, 2048, v5
  v_and_b32 v5, 2047, v5
  v_lshlrev_b32 v5, 3, v5
  v_add_u32 v5, 34816, v5
  ds_read_b64 v[108:109], v5
  v_add_u32 v5, 1600, v3
  v_sub_u32 v5, 2048, v5
  v_and_b32 v5, 2047, v5
  v_lshlrev_b32 v5, 3, v5
  v_add_u32 v5, 34816, v5
  ds_read_b64 v[110:111], v5
  s_waitcnt lgkmcnt(0)
  v_pk_mul_f32 v[92:93], v[16:17], v[128:129] op_sel:[0,0] op_sel_hi:[1,0]
  v_pk_fma_f32 v[16:17], v[16:17], v[128:129], v[92:93] op_sel:[1,1,0] op_sel_hi:[0,1,1] neg_lo:[0,1,0]
  v_pk_mul_f32 v[92:93], v[96:97], v[130:131] op_sel:[0,0] op_sel_hi:[1,0] neg_hi:[1,0]
  v_pk_fma_f32 v[92:93], v[96:97], v[130:131], v[92:93] op_sel:[1,1,0] op_sel_hi:[0,1,1]
  v_pk_add_f32 v[16:17], v[16:17], v[92:93]
  v_pk_mul_f32 v[92:93], v[24:25], v[132:133] op_sel:[0,0] op_sel_hi:[1,0]
  v_pk_fma_f32 v[24:25], v[24:25], v[132:133], v[92:93] op_sel:[1,1,0] op_sel_hi:[0,1,1] neg_lo:[0,1,0]
  v_pk_mul_f32 v[92:93], v[98:99], v[134:135] op_sel:[0,0] op_sel_hi:[1,0] neg_hi:[1,0]
  v_pk_fma_f32 v[92:93], v[98:99], v[134:135], v[92:93] op_sel:[1,1,0] op_sel_hi:[0,1,1]
  v_pk_add_f32 v[24:25], v[24:25], v[92:93]
  v_pk_mul_f32 v[92:93], v[32:33], v[136:137] op_sel:[0,0] op_sel_hi:[1,0]
  v_pk_fma_f32 v[32:33], v[32:33], v[136:137], v[92:93] op_sel:[1,1,0] op_sel_hi:[0,1,1] neg_lo:[0,1,0]
  v_pk_mul_f32 v[92:93], v[100:101], v[138:139] op_sel:[0,0] op_sel_hi:[1,0] neg_hi:[1,0]
  v_pk_fma_f32 v[92:93], v[100:101], v[138:139], v[92:93] op_sel:[1,1,0] op_sel_hi:[0,1,1]
  v_pk_add_f32 v[32:33], v[32:33], v[92:93]
  v_pk_mul_f32 v[92:93], v[36:37], v[140:141] op_sel:[0,0] op_sel_hi:[1,0]
  v_pk_fma_f32 v[36:37], v[36:37], v[140:141], v[92:93] op_sel:[1,1,0] op_sel_hi:[0,1,1] neg_lo:[0,1,0]
  v_pk_mul_f32 v[92:93], v[102:103], v[142:143] op_sel:[0,0] op_sel_hi:[1,0] neg_hi:[1,0]
  v_pk_fma_f32 v[92:93], v[102:103], v[142:143], v[92:93] op_sel:[1,1,0] op_sel_hi:[0,1,1]
  v_pk_add_f32 v[36:37], v[36:37], v[92:93]
  v_pk_mul_f32 v[92:93], v[18:19], v[144:145] op_sel:[0,0] op_sel_hi:[1,0]
  v_pk_fma_f32 v[18:19], v[18:19], v[144:145], v[92:93] op_sel:[1,1,0] op_sel_hi:[0,1,1] neg_lo:[0,1,0]
  v_pk_mul_f32 v[92:93], v[104:105], v[146:147] op_sel:[0,0] op_sel_hi:[1,0] neg_hi:[1,0]
  v_pk_fma_f32 v[92:93], v[104:105], v[146:147], v[92:93] op_sel:[1,1,0] op_sel_hi:[0,1,1]
  v_pk_add_f32 v[18:19], v[18:19], v[92:93]
  v_pk_mul_f32 v[92:93], v[26:27], v[148:149] op_sel:[0,0] op_sel_hi:[1,0]
  v_pk_fma_f32 v[26:27], v[26:27], v[148:149], v[92:93] op_sel:[1,1,0] op_sel_hi:[0,1,1] neg_lo:[0,1,0]
  v_pk_mul_f32 v[92:93], v[106:107], v[150:151] op_sel:[0,0] op_sel_hi:[1,0] neg_hi:[1,0]
  v_pk_fma_f32 v[92:93], v[106:107], v[150:151], v[92:93] op_sel:[1,1,0] op_sel_hi:[0,1,1]
  v_pk_add_f32 v[26:27], v[26:27], v[92:93]
  v_pk_mul_f32 v[92:93], v[34:35], v[152:153] op_sel:[0,0] op_sel_hi:[1,0]
  v_pk_fma_f32 v[34:35], v[34:35], v[152:153], v[92:93] op_sel:[1,1,0] op_sel_hi:[0,1,1] neg_lo:[0,1,0]
  v_pk_mul_f32 v[92:93], v[108:109], v[154:155] op_sel:[0,0] op_sel_hi:[1,0] neg_hi:[1,0]
  v_pk_fma_f32 v[92:93], v[108:109], v[154:155], v[92:93] op_sel:[1,1,0] op_sel_hi:[0,1,1]
  v_pk_add_f32 v[34:35], v[34:35], v[92:93]
  v_pk_mul_f32 v[92:93], v[38:39], v[156:157] op_sel:[0,0] op_sel_hi:[1,0]
  v_pk_fma_f32 v[38:39], v[38:39], v[156:157], v[92:93] op_sel:[1,1,0] op_sel_hi:[0,1,1] neg_lo:[0,1,0]
  v_pk_mul_f32 v[92:93], v[110:111], v[158:159] op_sel:[0,0] op_sel_hi:[1,0] neg_hi:[1,0]
  v_pk_fma_f32 v[92:93], v[110:111], v[158:159], v[92:93] op_sel:[1,1,0] op_sel_hi:[0,1,1]
  v_pk_add_f32 v[38:39], v[38:39], v[92:93]
l2_inv:
  v_pk_add_f32 v[20:21], v[16:17], v[18:19]
  v_pk_add_f32 v[18:19], v[16:17], v[18:19] neg_lo:[0,1] neg_hi:[0,1]
  v_pk_add_f32 v[22:23], v[32:33], v[34:35]
  v_pk_add_f32 v[34:35], v[32:33], v[34:35] neg_lo:[0,1] neg_hi:[0,1]
  v_pk_add_f32 v[16:17], v[20:21], v[22:23]
  v_pk_add_f32 v[32:33], v[20:21], v[22:23] neg_lo:[0,1] neg_hi:[0,1]
  v_pk_add_f32 v[20:21], v[18:19], v[34:35] op_sel:[0,1] op_sel_hi:[1,0] neg_lo:[0,1]
  v_pk_add_f32 v[22:23], v[18:19], v[34:35] op_sel:[0,1] op_sel_hi:[1,0] neg_hi:[0,1]
  v_pk_add_f32 v[28:29], v[24:25], v[26:27]
  v_pk_add_f32 v[26:27], v[24:25], v[26:27] neg_lo:[0,1] neg_hi:[0,1]
  v_pk_add_f32 v[30:31], v[36:37], v[38:39]
  v_pk_add_f32 v[38:39], v[36:37], v[38:39] neg_lo:[0,1] neg_hi:[0,1]
  v_pk_add_f32 v[24:25], v[28:29], v[30:31]
  v_pk_add_f32 v[36:37], v[28:29], v[30:31] neg_lo:[0,1] neg_hi:[0,1]
  v_pk_add_f32 v[28:29], v[26:27], v[38:39] op_sel:[0,1] op_sel_hi:[1,0] neg_lo:[0,1]
  v_pk_add_f32 v[30:31], v[26:27], v[38:39] op_sel:[0,1] op_sel_hi:[1,0] neg_hi:[0,1]
  ds_write_b64 v15, v[16:17] offset:0
  ds_write_b64 v15, v[24:25] offset:32
  ds_write_b64 v15, v[20:21] offset:8
  ds_write_b64 v15, v[28:29] offset:40
  ds_write_b64 v15, v[32:33] offset:16
  ds_write_b64 v15, v[36:37] offset:48
  ds_write_b64 v15, v[22:23] offset:24
  ds_write_b64 v15, v[30:31] offset:56
  ds_read_b64 v[16:17], v14 offset:0
  ds_read_b64 v[18:19], v14 offset:32
  ds_read_b64 v[20:21], v14 offset:64
  ds_read_b64 v[22:23], v14 offset:96
  ds_read_b64 v[24:25], v14 offset:128
  ds_read_b64 v[26:27], v14 offset:160
  ds_read_b64 v[28:29], v14 offset:192
  ds_read_b64 v[30:31], v14 offset:224
  s_waitcnt lgkmcnt(0)
  v_pk_mul_f32 v[32:33], v[18:19], v[76:77] op_sel:[0,0] op_sel_hi:[1,0]
  v_pk_fma_f32 v[18:19], v[18:19], v[76:77], v[32:33] op_sel:[1,1,0] op_sel_hi:[0,1,1] neg_hi:[0,1,0]
  v_pk_mul_f32 v[32:33], v[20:21], v[78:79] op_sel:[0,0] op_sel_hi:[1,0]
  v_pk_fma_f32 v[20:21], v[20:21], v[78:79], v[32:33] op_sel:[1,1,0] op_sel_hi:[0,1,1] neg_hi:[0,1,0]
  v_pk_mul_f32 v[32:33], v[22:23], v[80:81] op_sel:[0,0] op_sel_hi:[1,0]
  v_pk_fma_f32 v[22:23], v[22:23], v[80:81], v[32:33] op_sel:[1,1,0] op_sel_hi:[0,1,1] neg_hi:[0,1,0]
  v_pk_mul_f32 v[32:33], v[24:25], v[82:83] op_sel:[0,0] op_sel_hi:[1,0]
  v_pk_fma_f32 v[24:25], v[24:25], v[82:83], v[32:33] op_sel:[1,1,0] op_sel_hi:[0,1,1] neg_hi:[0,1,0]
  v_pk_mul_f32 v[32:33], v[26:27], v[84:85] op_sel:[0,0] op_sel_hi:[1,0]
  v_pk_fma_f32 v[26:27], v[26:27], v[84:85], v[32:33] op_sel:[1,1,0] op_sel_hi:[0,1,1] neg_hi:[0,1,0]
  v_pk_mul_f32 v[32:33], v[28:29], v[86:87] op_sel:[0,0] op_sel_hi:[1,0]
  v_pk_fma_f32 v[28:29], v[28:29], v[86:87], v[32:33] op_sel:[1,1,0] op_sel_hi:[0,1,1] neg_hi:[0,1,0]
  v_pk_mul_f32 v[32:33], v[30:31], v[88:89] op_sel:[0,0] op_sel_hi:[1,0]
  v_pk_fma_f32 v[30:31], v[30:31], v[88:89], v[32:33] op_sel:[1,1,0] op_sel_hi:[0,1,1] neg_hi:[0,1,0]
  v_pk_add_f32 v[32:33], v[16:17], v[24:25]
  v_pk_add_f32 v[24:25], v[16:17], v[24:25] neg_lo:[0,1] neg_hi:[0,1]
  v_pk_add_f32 v[34:35], v[18:19], v[26:27]
  v_pk_add_f32 v[26:27], v[18:19], v[26:27] neg_lo:[0,1] neg_hi:[0,1]
  v_pk_add_f32 v[36:37], v[20:21], v[28:29]
  v_pk_add_f32 v[28:29], v[20:21], v[28:29] neg_lo:[0,1] neg_hi:[0,1]
  v_pk_add_f32 v[38:39], v[22:23], v[30:31]
  v_pk_add_f32 v[30:31], v[22:23], v[30:31] neg_lo:[0,1] neg_hi:[0,1]
  v_pk_add_f32 v[16:17], v[32:33], v[36:37]
  v_pk_add_f32 v[18:19], v[32:33], v[36:37] neg_lo:[0,1] neg_hi:[0,1]
  v_pk_add_f32 v[20:21], v[34:35], v[38:39]
  v_pk_add_f32 v[22:23], v[34:35], v[38:39] neg_lo:[0,1] neg_hi:[0,1]
  v_pk_add_f32 v[32:33], v[16:17], v[20:21]
  v_pk_add_f32 v[34:35], v[16:17], v[20:21] neg_lo:[0,1] neg_hi:[0,1]
  v_pk_add_f32 v[36:37], v[18:19], v[22:23] op_sel:[0,1] op_sel_hi:[1,0] neg_lo:[0,1]
  v_pk_add_f32 v[38:39], v[18:19], v[22:23] op_sel:[0,1] op_sel_hi:[1,0] neg_hi:[0,1]
  v_pk_add_f32 v[16:17], v[24:25], v[28:29] op_sel:[0,1] op_sel_hi:[1,0] neg_lo:[0,1]
  v_pk_add_f32 v[18:19], v[24:25], v[28:29] op_sel:[0,1] op_sel_hi:[1,0] neg_hi:[0,1]
  v_pk_add_f32 v[20:21], v[26:27], v[26:27] op_sel:[0,1] op_sel_hi:[1,0] neg_lo:[0,1]
  v_pk_add_f32 v[22:23], v[30:31], v[30:31] op_sel:[0,1] op_sel_hi:[1,0] neg_hi:[0,1]
  v_pk_add_f32 v[24:25], v[20:21], v[22:23] neg_lo:[0,1] neg_hi:[0,1]
  v_pk_add_f32 v[26:27], v[20:21], v[22:23]
  v_pk_fma_f32 v[28:29], v[24:25], s[60:61], v[16:17]
  v_pk_fma_f32 v[30:31], v[24:25], s[60:61], v[16:17] neg_lo:[1,0,0] neg_hi:[1,0,0]
  v_pk_fma_f32 v[20:21], v[26:27], s[60:61], v[18:19] op_sel:[1,0,0] op_sel_hi:[0,1,1] neg_lo:[1,0,0]
  v_pk_fma_f32 v[22:23], v[26:27], s[60:61], v[18:19] op_sel:[1,0,0] op_sel_hi:[0,1,1] neg_hi:[1,0,0]
  ds_write_b64 v14, v[32:33] offset:0
  ds_write_b64 v14, v[28:29] offset:32
  ds_write_b64 v14, v[36:37] offset:64
  ds_write_b64 v14, v[20:21] offset:96
  ds_write_b64 v14, v[34:35] offset:128
  ds_write_b64 v14, v[30:31] offset:160
  ds_write_b64 v14, v[38:39] offset:192
  ds_write_b64 v14, v[22:23] offset:224
  ds_read_b64 v[32:33], v13 offset:0
  ds_read_b64 v[28:29], v13 offset:288
  ds_read_b64 v[36:37], v13 offset:576
  ds_read_b64 v[20:21], v13 offset:864
  ds_read_b64 v[34:35], v13 offset:1152
  ds_read_b64 v[30:31], v13 offset:1440
  ds_read_b64 v[38:39], v13 offset:1728
  ds_read_b64 v[22:23], v13 offset:2016
  s_waitcnt lgkmcnt(0)
  v_pk_mul_f32 v[16:17], v[28:29], v[62:63] op_sel:[0,0] op_sel_hi:[1,0]
  v_pk_fma_f32 v[28:29], v[28:29], v[62:63], v[16:17] op_sel:[1,1,0] op_sel_hi:[0,1,1] neg_hi:[0,1,0]
  v_pk_mul_f32 v[16:17], v[36:37], v[64:65] op_sel:[0,0] op_sel_hi:[1,0]
  v_pk_fma_f32 v[36:37], v[36:37], v[64:65], v[16:17] op_sel:[1,1,0] op_sel_hi:[0,1,1] neg_hi:[0,1,0]
  v_pk_mul_f32 v[16:17], v[20:21], v[66:67] op_sel:[0,0] op_sel_hi:[1,0]
  v_pk_fma_f32 v[20:21], v[20:21], v[66:67], v[16:17] op_sel:[1,1,0] op_sel_hi:[0,1,1] neg_hi:[0,1,0]
  v_pk_mul_f32 v[16:17], v[34:35], v[68:69] op_sel:[0,0] op_sel_hi:[1,0]
  v_pk_fma_f32 v[34:35], v[34:35], v[68:69], v[16:17] op_sel:[1,1,0] op_sel_hi:[0,1,1] neg_hi:[0,1,0]
  v_pk_mul_f32 v[16:17], v[30:31], v[70:71] op_sel:[0,0] op_sel_hi:[1,0]
  v_pk_fma_f32 v[30:31], v[30:31], v[70:71], v[16:17] op_sel:[1,1,0] op_sel_hi:[0,1,1] neg_hi:[0,1,0]
  v_pk_mul_f32 v[16:17], v[38:39], v[72:73] op_sel:[0,0] op_sel_hi:[1,0]
  v_pk_fma_f32 v[38:39], v[38:39], v[72:73], v[16:17] op_sel:[1,1,0] op_sel_hi:[0,1,1] neg_hi:[0,1,0]
  v_pk_mul_f32 v[16:17], v[22:23], v[74:75] op_sel:[0,0] op_sel_hi:[1,0]
  v_pk_fma_f32 v[22:23], v[22:23], v[74:75], v[16:17] op_sel:[1,1,0] op_sel_hi:[0,1,1] neg_hi:[0,1,0]
  v_pk_add_f32 v[16:17], v[32:33], v[34:35]
  v_pk_add_f32 v[34:35], v[32:33], v[34:35] neg_lo:[0,1] neg_hi:[0,1]
  v_pk_add_f32 v[18:19], v[28:29], v[30:31]
  v_pk_add_f32 v[30:31], v[28:29], v[30:31] neg_lo:[0,1] neg_hi:[0,1]
  v_pk_add_f32 v[24:25], v[36:37], v[38:39]
  v_pk_add_f32 v[38:39], v[36:37], v[38:39] neg_lo:[0,1] neg_hi:[0,1]
  v_pk_add_f32 v[26:27], v[20:21], v[22:23]
  v_pk_add_f32 v[22:23], v[20:21], v[22:23] neg_lo:[0,1] neg_hi:[0,1]
  v_pk_add_f32 v[32:33], v[16:17], v[24:25]
  v_pk_add_f32 v[28:29], v[16:17], v[24:25] neg_lo:[0,1] neg_hi:[0,1]
  v_pk_add_f32 v[36:37], v[18:19], v[26:27]
  v_pk_add_f32 v[20:21], v[18:19], v[26:27] neg_lo:[0,1] neg_hi:[0,1]
  v_pk_add_f32 v[16:17], v[32:33], v[36:37]
  v_pk_add_f32 v[18:19], v[32:33], v[36:37] neg_lo:[0,1] neg_hi:[0,1]
  v_pk_add_f32 v[24:25], v[28:29], v[20:21] op_sel:[0,1] op_sel_hi:[1,0] neg_lo:[0,1]
  v_pk_add_f32 v[26:27], v[28:29], v[20:21] op_sel:[0,1] op_sel_hi:[1,0] neg_hi:[0,1]
  v_pk_add_f32 v[32:33], v[34:35], v[38:39] op_sel:[0,1] op_sel_hi:[1,0] neg_lo:[0,1]
  v_pk_add_f32 v[28:29], v[34:35], v[38:39] op_sel:[0,1] op_sel_hi:[1,0] neg_hi:[0,1]
  v_pk_add_f32 v[36:37], v[30:31], v[30:31] op_sel:[0,1] op_sel_hi:[1,0] neg_lo:[0,1]
  v_pk_add_f32 v[20:21], v[22:23], v[22:23] op_sel:[0,1] op_sel_hi:[1,0] neg_hi:[0,1]
  v_pk_add_f32 v[34:35], v[36:37], v[20:21] neg_lo:[0,1] neg_hi:[0,1]
  v_pk_add_f32 v[30:31], v[36:37], v[20:21]
  v_pk_fma_f32 v[38:39], v[34:35], s[60:61], v[32:33]
  v_pk_fma_f32 v[22:23], v[34:35], s[60:61], v[32:33] neg_lo:[1,0,0] neg_hi:[1,0,0]
  v_pk_fma_f32 v[36:37], v[30:31], s[60:61], v[28:29] op_sel:[1,0,0] op_sel_hi:[0,1,1] neg_lo:[1,0,0]
  v_pk_fma_f32 v[20:21], v[30:31], s[60:61], v[28:29] op_sel:[1,0,0] op_sel_hi:[0,1,1] neg_hi:[1,0,0]
  ds_write_b64 v11, v[16:17] offset:0
  ds_write_b64 v11, v[38:39] offset:256
  ds_write_b64 v11, v[24:25] offset:512
  ds_write_b64 v11, v[36:37] offset:768
  ds_write_b64 v11, v[18:19] offset:1024
  ds_write_b64 v11, v[22:23] offset:1280
  ds_write_b64 v11, v[26:27] offset:1536
  ds_write_b64 v11, v[20:21] offset:1792
  s_waitcnt lgkmcnt(0)
  s_barrier
  ds_read_b64 v[16:17], v9 offset:0
  ds_read_b64 v[38:39], v9 offset:2048
  ds_read_b64 v[24:25], v9 offset:4096
  ds_read_b64 v[36:37], v9 offset:6144
  ds_read_b64 v[18:19], v9 offset:8192
  ds_read_b64 v[22:23], v9 offset:10240
  ds_read_b64 v[26:27], v9 offset:12288
  ds_read_b64 v[20:21], v9 offset:14336
  s_waitcnt lgkmcnt(0)
  v_pk_mul_f32 v[32:33], v[38:39], v[48:49] op_sel:[0,0] op_sel_hi:[1,0]
  v_pk_fma_f32 v[38:39], v[38:39], v[48:49], v[32:33] op_sel:[1,1,0] op_sel_hi:[0,1,1] neg_hi:[0,1,0]
  v_pk_mul_f32 v[32:33], v[24:25], v[50:51] op_sel:[0,0] op_sel_hi:[1,0]
  v_pk_fma_f32 v[24:25], v[24:25], v[50:51], v[32:33] op_sel:[1,1,0] op_sel_hi:[0,1,1] neg_hi:[0,1,0]
  v_pk_mul_f32 v[32:33], v[36:37], v[52:53] op_sel:[0,0] op_sel_hi:[1,0]
  v_pk_fma_f32 v[36:37], v[36:37], v[52:53], v[32:33] op_sel:[1,1,0] op_sel_hi:[0,1,1] neg_hi:[0,1,0]
  v_pk_mul_f32 v[32:33], v[18:19], v[54:55] op_sel:[0,0] op_sel_hi:[1,0]
  v_pk_fma_f32 v[18:19], v[18:19], v[54:55], v[32:33] op_sel:[1,1,0] op_sel_hi:[0,1,1] neg_hi:[0,1,0]
  v_pk_mul_f32 v[32:33], v[22:23], v[56:57] op_sel:[0,0] op_sel_hi:[1,0]
  v_pk_fma_f32 v[22:23], v[22:23], v[56:57], v[32:33] op_sel:[1,1,0] op_sel_hi:[0,1,1] neg_hi:[0,1,0]
  v_pk_mul_f32 v[32:33], v[26:27], v[58:59] op_sel:[0,0] op_sel_hi:[1,0]
  v_pk_fma_f32 v[26:27], v[26:27], v[58:59], v[32:33] op_sel:[1,1,0] op_sel_hi:[0,1,1] neg_hi:[0,1,0]
  v_pk_mul_f32 v[32:33], v[20:21], v[60:61] op_sel:[0,0] op_sel_hi:[1,0]
  v_pk_fma_f32 v[20:21], v[20:21], v[60:61], v[32:33] op_sel:[1,1,0] op_sel_hi:[0,1,1] neg_hi:[0,1,0]
  v_pk_add_f32 v[32:33], v[16:17], v[18:19]
  v_pk_add_f32 v[18:19], v[16:17], v[18:19] neg_lo:[0,1] neg_hi:[0,1]
  v_pk_add_f32 v[28:29], v[38:39], v[22:23]
  v_pk_add_f32 v[22:23], v[38:39], v[22:23] neg_lo:[0,1] neg_hi:[0,1]
  v_pk_add_f32 v[34:35], v[24:25], v[26:27]
  v_pk_add_f32 v[26:27], v[24:25], v[26:27] neg_lo:[0,1] neg_hi:[0,1]
  v_pk_add_f32 v[30:31], v[36:37], v[20:21]
  v_pk_add_f32 v[20:21], v[36:37], v[20:21] neg_lo:[0,1] neg_hi:[0,1]
  v_pk_add_f32 v[16:17], v[32:33], v[34:35]
  v_pk_add_f32 v[38:39], v[32:33], v[34:35] neg_lo:[0,1] neg_hi:[0,1]
  v_pk_add_f32 v[24:25], v[28:29], v[30:31]
  v_pk_add_f32 v[36:37], v[28:29], v[30:31] neg_lo:[0,1] neg_hi:[0,1]
  v_pk_add_f32 v[32:33], v[16:17], v[24:25]
  v_pk_add_f32 v[28:29], v[16:17], v[24:25] neg_lo:[0,1] neg_hi:[0,1]
  v_pk_add_f32 v[34:35], v[38:39], v[36:37] op_sel:[0,1] op_sel_hi:[1,0] neg_lo:[0,1]
  v_pk_add_f32 v[30:31], v[38:39], v[36:37] op_sel:[0,1] op_sel_hi:[1,0] neg_hi:[0,1]
  v_pk_add_f32 v[16:17], v[18:19], v[26:27] op_sel:[0,1] op_sel_hi:[1,0] neg_lo:[0,1]
  v_pk_add_f32 v[38:39], v[18:19], v[26:27] op_sel:[0,1] op_sel_hi:[1,0] neg_hi:[0,1]
  v_pk_add_f32 v[24:25], v[22:23], v[22:23] op_sel:[0,1] op_sel_hi:[1,0] neg_lo:[0,1]
  v_pk_add_f32 v[36:37], v[20:21], v[20:21] op_sel:[0,1] op_sel_hi:[1,0] neg_hi:[0,1]
  v_pk_add_f32 v[18:19], v[24:25], v[36:37] neg_lo:[0,1] neg_hi:[0,1]
  v_pk_add_f32 v[22:23], v[24:25], v[36:37]
  v_pk_fma_f32 v[26:27], v[18:19], s[60:61], v[16:17]
  v_pk_fma_f32 v[20:21], v[18:19], s[60:61], v[16:17] neg_lo:[1,0,0] neg_hi:[1,0,0]
  v_pk_fma_f32 v[24:25], v[22:23], s[60:61], v[38:39] op_sel:[1,0,0] op_sel_hi:[0,1,1] neg_lo:[1,0,0]
  v_pk_fma_f32 v[36:37], v[22:23], s[60:61], v[38:39] op_sel:[1,0,0] op_sel_hi:[0,1,1] neg_hi:[1,0,0]
  buffer_store_dwordx2 v[32:33], v1, s[20:23], 0 offen offset:0 sc1
  buffer_store_dwordx2 v[26:27], v1, s[20:23], 0 offen offset:2048 sc1
  s_movk_i32 s19, 4096
  buffer_store_dwordx2 v[34:35], v1, s[20:23], s19 offen sc1
  s_movk_i32 s19, 6144
  buffer_store_dwordx2 v[24:25], v1, s[20:23], s19 offen sc1
  s_movk_i32 s19, 8192
  buffer_store_dwordx2 v[28:29], v1, s[20:23], s19 offen sc1
  s_movk_i32 s19, 10240
  buffer_store_dwordx2 v[20:21], v1, s[20:23], s19 offen sc1
  s_movk_i32 s19, 12288
  buffer_store_dwordx2 v[30:31], v1, s[20:23], s19 offen sc1
  s_movk_i32 s19, 14336
  buffer_store_dwordx2 v[36:37], v1, s[20:23], s19 offen sc1
  s_waitcnt vmcnt(0) lgkmcnt(0)
  s_barrier
  s_cmp_lg_u32 s95, 0
  s_cbranch_scc1 arr_skip_c
  s_mov_b64 s[92:93], exec
  s_mov_b64 exec, 1
  s_lshl_b32 s94, s2, 6
  v_mov_b32 v255, s94
  v_mov_b32 v254, 3
  buffer_store_dword v254, v255, s[76:79], 0 offen sc1
  s_mov_b64 exec, s[92:93]
arr_skip_c:
  v_mov_b32 v252, 151552
  ds_read_b64 v[254:255], v252
  s_waitcnt lgkmcnt(0)
  v_readfirstlane_b32 s71, v254
  v_readfirstlane_b32 s69, v255
  s_nop 3
  s_mov_b32 s60, 0x3f3504f3
  s_mov_b32 s61, 0x3f3504f3
  s_load_dwordx2 s[6:7], s[0:1], 0
  v_and_b32 v1, 31, v0
  v_lshrrev_b32 v2, 5, v0
  v_lshrrev_b32 v8, 3, v0
  v_and_b32 v14, 7, v0
  v_sub_u32 v9, 64, v8
  v_cmp_eq_u32 vcc, 0, v8
  v_mov_b32 v10, 32
  s_nop 1
  v_cndmask_b32 v9, v9, v10, vcc
  s_mov_b64 s[56:57], vcc
  s_lshl_b32 s3, s71, 6
  v_lshl_add_u32 v12, v14, 3, s3
  v_lshl_add_u32 v13, v8, 14, v12
  v_lshl_add_u32 v11, v9, 14, v12
  s_mov_b32 s40, 0x0
  s_mov_b32 s41, 0x100000
  s_mov_b32 s42, 0x200000
  s_mov_b32 s43, 0x300000
  s_waitcnt lgkmcnt(0)
  s_mov_b32 s8, s6
  s_mov_b32 s9, s7
  s_mov_b32 s10, 0x200000
  s_mov_b32 s11, 0x00020000
  s_mov_b32 s12, s4
  s_mov_b32 s13, s5
  s_mov_b32 s14, 0x3000
  s_mov_b32 s15, 0x00020000
  s_add_u32 s16, s4, 0x990000
  s_addc_u32 s17, s5, 0
  s_mov_b32 s18, 0x400000
  s_mov_b32 s19, 0x00020000
  s_add_u32 s20, s4, 0xd90000
  s_addc_u32 s21, s5, 0
  s_mov_b32 s22, 0x200000
  s_mov_b32 s23, 0x00020000
  s_add_u32 s24, s4, 0xf90000
  s_addc_u32 s25, s5, 0
  s_mov_b32 s26, 0x200000
  s_mov_b32 s27, 0x00020000
  s_lshl_b32 s3, s71, 13
  v_lshl_add_u32 v3, v2, 10, s3
  v_lshl_add_u32 v3, v1, 2, v3
  v_lshlrev_b32 v4, 3, v1
  buffer_load_dword v40, v3, s[8:11], 0 offen offset:0
  buffer_load_dword v41, v3, s[8:11], 0 offen offset:128
  buffer_load_dword v42, v3, s[8:11], 0 offen offset:256
  buffer_load_dword v43, v3, s[8:11], 0 offen offset:384
  buffer_load_dword v44, v3, s[8:11], 0 offen offset:512
  buffer_load_dword v45, v3, s[8:11], 0 offen offset:640
  buffer_load_dword v46, v3, s[8:11], 0 offen offset:768
  buffer_load_dword v47, v3, s[8:11], 0 offen offset:896
  s_movk_i32 s45, 4096
  s_movk_i32 s46, 8192
  buffer_load_dwordx2 v[128:129], v4, s[12:15], s45 offen offset:0
  buffer_load_dwordx2 v[64:65], v4, s[12:15], s45 offen offset:2048
  buffer_load_dwordx2 v[48:49], v4, s[12:15], s46 offen offset:0
  buffer_load_dwordx2 v[130:131], v4, s[12:15], s45 offen offset:256
  buffer_load_dwordx2 v[66:67], v4, s[12:15], s45 offen offset:2304
  buffer_load_dwordx2 v[50:51], v4, s[12:15], s46 offen offset:256
  buffer_load_dwordx2 v[132:133], v4, s[12:15], s45 offen offset:512
  buffer_load_dwordx2 v[68:69], v4, s[12:15], s45 offen offset:2560
  buffer_load_dwordx2 v[52:53], v4, s[12:15], s46 offen offset:512
  buffer_load_dwordx2 v[134:135], v4, s[12:15], s45 offen offset:768
  buffer_load_dwordx2 v[70:71], v4, s[12:15], s45 offen offset:2816
  buffer_load_dwordx2 v[54:55], v4, s[12:15], s46 offen offset:768
  buffer_load_dwordx2 v[136:137], v4, s[12:15], s45 offen offset:1024
  buffer_load_dwordx2 v[72:73], v4, s[12:15], s45 offen offset:3072
  buffer_load_dwordx2 v[56:57], v4, s[12:15], s46 offen offset:1024
  buffer_load_dwordx2 v[138:139], v4, s[12:15], s45 offen offset:1280
  buffer_load_dwordx2 v[74:75], v4, s[12:15], s45 offen offset:3328
  buffer_load_dwordx2 v[58:59], v4, s[12:15], s46 offen offset:1280
  buffer_load_dwordx2 v[140:141], v4, s[12:15], s45 offen offset:1536
  buffer_load_dwordx2 v[76:77], v4, s[12:15], s45 offen offset:3584
  buffer_load_dwordx2 v[60:61], v4, s[12:15], s46 offen offset:1536
  buffer_load_dwordx2 v[142:143], v4, s[12:15], s45 offen offset:1792
  buffer_load_dwordx2 v[78:79], v4, s[12:15], s45 offen offset:3840
  buffer_load_dwordx2 v[62:63], v4, s[12:15], s46 offen offset:1792
  v_cvt_f32_u32 v5, v1
  v_mul_f32 v5, 0x3b800000, v5
  v_cos_f32 v80, v5
  v_sin_f32 v81, -v5
  v_mul_f32 v6, 2.0, v5
  v_cos_f32 v82, v6
  v_sin_f32 v83, -v6
  v_mul_f32 v6, 0x40400000, v5
  v_cos_f32 v84, v6
  v_sin_f32 v85, -v6
  v_mul_f32 v6, 4.0, v5
  v_cos_f32 v86, v6
  v_sin_f32 v87, -v6
  v_mul_f32 v6, 0x40a00000, v5
  v_cos_f32 v88, v6
  v_sin_f32 v89, -v6
  v_mul_f32 v6, 0x40c00000, v5
  v_cos_f32 v90, v6
  v_sin_f32 v91, -v6
  v_mul_f32 v6, 0x40e00000, v5
  v_cos_f32 v92, v6
  v_sin_f32 v93, -v6
  v_and_b32 v7, 3, v0
  v_cvt_f32_u32 v5, v7
  v_mul_f32 v5, 0x3d000000, v5
  v_cos_f32 v94, v5
  v_sin_f32 v95, -v5
  v_mul_f32 v6, 2.0, v5
  v_cos_f32 v96, v6
  v_sin_f32 v97, -v6
  v_mul_f32 v6, 0x40400000, v5
  v_cos_f32 v98, v6
  v_sin_f32 v99, -v6
  v_mul_f32 v6, 4.0, v5
  v_cos_f32 v100, v6
  v_sin_f32 v101, -v6
  v_mul_f32 v6, 0x40a00000, v5
  v_cos_f32 v102, v6
  v_sin_f32 v103, -v6
  v_mul_f32 v6, 0x40c00000, v5
  v_cos_f32 v104, v6
  v_sin_f32 v105, -v6
  v_mul_f32 v6, 0x40e00000, v5
  v_cos_f32 v106, v6
  v_sin_f32 v107, -v6
  v_cvt_f32_u32 v5, v8
  v_mul_f32 v5, 0x3b000000, v5
  v_add_f32 v6, 0x00000000, v5
  v_cos_f32 v108, v6
  v_sin_f32 v109, -v6
  v_add_f32 v6, 0x3e000000, v5
  v_cos_f32 v110, v6
  v_sin_f32 v111, -v6
  v_add_f32 v6, 0x3e800000, v5
  v_cos_f32 v112, v6
  v_sin_f32 v113, -v6
  v_add_f32 v6, 0x3ec00000, v5
  v_cos_f32 v114, v6
  v_sin_f32 v115, -v6
  v_mul_u32_u24 v15, 2064, v14
  v_add_u32 v15, 18432, v15
  v_lshl_add_u32 v10, v8, 5, v15
  v_lshl_add_u32 v15, v9, 5, v15
  s_waitcnt vmcnt(0)
  s_cmp_lg_u32 s95, 0
  s_cbranch_scc1 wait_skip_c
  v_and_b32 v253, 63, v0
  v_lshlrev_b32 v253, 6, v253
wait_loop_c:
  s_movk_i32 s94, 0
  buffer_load_dword v249, v253, s[76:79], s94 offen sc1
  s_movk_i32 s94, 4096
  buffer_load_dword v250, v253, s[76:79], s94 offen sc1
  s_movk_i32 s94, 8192
  buffer_load_dword v251, v253, s[76:79], s94 offen sc1
  s_movk_i32 s94, 12288
  buffer_load_dword v252, v253, s[76:79], s94 offen sc1
  s_waitcnt vmcnt(0)
  v_min_u32 v249, v249, v250
  v_min_u32 v251, v251, v252
  v_min_u32 v249, v249, v251
  v_cmp_gt_u32 vcc, 3, v249
  s_cmp_eq_u64 vcc, 0
  s_cbranch_scc1 wait_skip_c
  s_sleep 3
  s_branch wait_loop_c
wait_skip_c:
  s_barrier
  buffer_load_dwordx2 v[16:17], v13, s[16:19], s40 offen
  buffer_load_dwordx2 v[24:25], v11, s[16:19], s40 offen
  buffer_load_dwordx2 v[18:19], v13, s[16:19], s41 offen
  buffer_load_dwordx2 v[26:27], v11, s[16:19], s41 offen
  buffer_load_dwordx2 v[20:21], v13, s[16:19], s42 offen
  buffer_load_dwordx2 v[28:29], v11, s[16:19], s42 offen
  buffer_load_dwordx2 v[22:23], v13, s[16:19], s43 offen
  buffer_load_dwordx2 v[30:31], v11, s[16:19], s43 offen
  s_waitcnt vmcnt(0)
  s_mov_b64 vcc, s[56:57]
  s_mov_b64 s[50:51], exec
  s_andn2_b64 exec, exec, vcc
  v_pk_add_f32 v[34:35], v[16:17], v[30:31] neg_hi:[0,1]
  v_pk_add_f32 v[36:37], v[16:17], v[30:31] neg_lo:[0,1]
  v_pk_mul_f32 v[38:39], v[36:37], v[108:109] op_sel:[1,0] op_sel_hi:[0,0] neg_lo:[1,0]
  v_pk_fma_f32 v[38:39], v[36:37], v[108:109], v[38:39] op_sel:[0,1,0] op_sel_hi:[1,1,1]
  v_pk_add_f32 v[144:145], v[34:35], v[38:39]
  v_pk_add_f32 v[158:159], v[34:35], v[38:39] neg_lo:[0,1] neg_hi:[1,0]
  v_pk_add_f32 v[34:35], v[18:19], v[28:29] neg_hi:[0,1]
  v_pk_add_f32 v[36:37], v[18:19], v[28:29] neg_lo:[0,1]
  v_pk_mul_f32 v[38:39], v[36:37], v[110:111] op_sel:[1,0] op_sel_hi:[0,0] neg_lo:[1,0]
  v_pk_fma_f32 v[38:39], v[36:37], v[110:111], v[38:39] op_sel:[0,1,0] op_sel_hi:[1,1,1]
  v_pk_add_f32 v[146:147], v[34:35], v[38:39]
  v_pk_add_f32 v[156:157], v[34:35], v[38:39] neg_lo:[0,1] neg_hi:[1,0]
  v_pk_add_f32 v[34:35], v[20:21], v[26:27] neg_hi:[0,1]
  v_pk_add_f32 v[36:37], v[20:21], v[26:27] neg_lo:[0,1]
  v_pk_mul_f32 v[38:39], v[36:37], v[112:113] op_sel:[1,0] op_sel_hi:[0,0] neg_lo:[1,0]
  v_pk_fma_f32 v[38:39], v[36:37], v[112:113], v[38:39] op_sel:[0,1,0] op_sel_hi:[1,1,1]
  v_pk_add_f32 v[148:149], v[34:35], v[38:39]
  v_pk_add_f32 v[154:155], v[34:35], v[38:39] neg_lo:[0,1] neg_hi:[1,0]
  v_pk_add_f32 v[34:35], v[22:23], v[24:25] neg_hi:[0,1]
  v_pk_add_f32 v[36:37], v[22:23], v[24:25] neg_lo:[0,1]
  v_pk_mul_f32 v[38:39], v[36:37], v[114:115] op_sel:[1,0] op_sel_hi:[0,0] neg_lo:[1,0]
  v_pk_fma_f32 v[38:39], v[36:37], v[114:115], v[38:39] op_sel:[0,1,0] op_sel_hi:[1,1,1]
  v_pk_add_f32 v[150:151], v[34:35], v[38:39]
  v_pk_add_f32 v[152:153], v[34:35], v[38:39] neg_lo:[0,1] neg_hi:[1,0]
  s_and_b64 exec, s[50:51], vcc
  s_cbranch_execz l3_nospecial
  v_mov_b32 v32, v17
  v_mov_b32 v17, 0
  v_mov_b32 v33, 0
  s_mov_b32 s52, 0x3f800000
  s_mov_b32 s53, 0x80000000
  v_pk_add_f32 v[34:35], v[16:17], v[32:33] neg_hi:[0,1]
  v_pk_add_f32 v[36:37], v[16:17], v[32:33] neg_lo:[0,1]
  v_pk_mul_f32 v[38:39], v[36:37], s[52:53] op_sel:[1,0] op_sel_hi:[0,0] neg_lo:[1,0]
  v_pk_fma_f32 v[38:39], v[36:37], s[52:53], v[38:39] op_sel:[0,1,0] op_sel_hi:[1,1,1]
  v_pk_add_f32 v[144:145], v[34:35], v[38:39]
  v_pk_add_f32 v[160:161], v[34:35], v[38:39] neg_lo:[0,1] neg_hi:[1,0]
  s_mov_b32 s52, 0x3f3504f3
  s_mov_b32 s53, 0xbf3504f3
  v_pk_add_f32 v[34:35], v[18:19], v[22:23] neg_hi:[0,1]
  v_pk_add_f32 v[36:37], v[18:19], v[22:23] neg_lo:[0,1]
  v_pk_mul_f32 v[38:39], v[36:37], s[52:53] op_sel:[1,0] op_sel_hi:[0,0] neg_lo:[1,0]
  v_pk_fma_f32 v[38:39], v[36:37], s[52:53], v[38:39] op_sel:[0,1,0] op_sel_hi:[1,1,1]
  v_pk_add_f32 v[146:147], v[34:35], v[38:39]
  v_pk_add_f32 v[150:151], v[34:35], v[38:39] neg_lo:[0,1] neg_hi:[1,0]
  s_mov_b32 s52, 0x248d3132
  s_mov_b32 s53, 0xbf800000
  v_pk_add_f32 v[34:35], v[20:21], v[20:21] neg_hi:[0,1]
  v_pk_add_f32 v[36:37], v[20:21], v[20:21] neg_lo:[0,1]
  v_pk_mul_f32 v[38:39], v[36:37], s[52:53] op_sel:[1,0] op_sel_hi:[0,0] neg_lo:[1,0]
  v_pk_fma_f32 v[38:39], v[36:37], s[52:53], v[38:39] op_sel:[0,1,0] op_sel_hi:[1,1,1]
  v_pk_add_f32 v[148:149], v[34:35], v[38:39]
  v_pk_add_f32 v[160:161], v[34:35], v[38:39] neg_lo:[0,1] neg_hi:[1,0]
  s_mov_b32 s52, 0x3f6c835e
  s_mov_b32 s53, 0xbec3ef15
  v_pk_add_f32 v[34:35], v[24:25], v[30:31] neg_hi:[0,1]
  v_pk_add_f32 v[36:37], v[24:25], v[30:31] neg_lo:[0,1]
  v_pk_mul_f32 v[38:39], v[36:37], s[52:53] op_sel:[1,0] op_sel_hi:[0,0] neg_lo:[1,0]
  v_pk_fma_f32 v[38:39], v[36:37], s[52:53], v[38:39] op_sel:[0,1,0] op_sel_hi:[1,1,1]
  v_pk_add_f32 v[152:153], v[34:35], v[38:39]
  v_pk_add_f32 v[158:159], v[34:35], v[38:39] neg_lo:[0,1] neg_hi:[1,0]
  s_mov_b32 s52, 0x3ec3ef15
  s_mov_b32 s53, 0xbf6c835e
  v_pk_add_f32 v[34:35], v[26:27], v[28:29] neg_hi:[0,1]
  v_pk_add_f32 v[36:37], v[26:27], v[28:29] neg_lo:[0,1]
  v_pk_mul_f32 v[38:39], v[36:37], s[52:53] op_sel:[1,0] op_sel_hi:[0,0] neg_lo:[1,0]
  v_pk_fma_f32 v[38:39], v[36:37], s[52:53], v[38:39] op_sel:[0,1,0] op_sel_hi:[1,1,1]
  v_pk_add_f32 v[154:155], v[34:35], v[38:39]
  v_pk_add_f32 v[156:157], v[34:35], v[38:39] neg_lo:[0,1] neg_hi:[1,0]
l3_nospecial:
  s_mov_b64 exec, s[50:51]
  v_pk_add_f32 v[16:17], v[144:145], v[148:149]
  v_pk_add_f32 v[148:149], v[144:145], v[148:149] neg_lo:[0,1] neg_hi:[0,1]
  v_pk_add_f32 v[18:19], v[146:147], v[150:151]
  v_pk_add_f32 v[150:151], v[146:147], v[150:151] neg_lo:[0,1] neg_hi:[0,1]
  v_pk_add_f32 v[144:145], v[16:17], v[18:19]
  v_pk_add_f32 v[146:147], v[16:17], v[18:19] neg_lo:[0,1] neg_hi:[0,1]
  v_pk_add_f32 v[16:17], v[148:149], v[150:151] op_sel:[0,1] op_sel_hi:[1,0] neg_lo:[0,1]
  v_pk_add_f32 v[18:19], v[148:149], v[150:151] op_sel:[0,1] op_sel_hi:[1,0] neg_hi:[0,1]
  v_pk_add_f32 v[20:21], v[152:153], v[156:157]
  v_pk_add_f32 v[156:157], v[152:153], v[156:157] neg_lo:[0,1] neg_hi:[0,1]
  v_pk_add_f32 v[22:23], v[154:155], v[158:159]
  v_pk_add_f32 v[158:159], v[154:155], v[158:159] neg_lo:[0,1] neg_hi:[0,1]
  v_pk_add_f32 v[152:153], v[20:21], v[22:23]
  v_pk_add_f32 v[154:155], v[20:21], v[22:23] neg_lo:[0,1] neg_hi:[0,1]
  v_pk_add_f32 v[20:21], v[156:157], v[158:159] op_sel:[0,1] op_sel_hi:[1,0] neg_lo:[0,1]
  v_pk_add_f32 v[22:23], v[156:157], v[158:159] op_sel:[0,1] op_sel_hi:[1,0] neg_hi:[0,1]
  ds_write_b64 v10, v[144:145] offset:0
  ds_write_b64 v15, v[152:153] offset:0
  ds_write_b64 v10, v[16:17] offset:8
  ds_write_b64 v15, v[20:21] offset:8
  ds_write_b64 v10, v[146:147] offset:16
  ds_write_b64 v15, v[154:155] offset:16
  ds_write_b64 v10, v[18:19] offset:24
  ds_write_b64 v15, v[22:23] offset:24
  s_waitcnt lgkmcnt(0)
  s_barrier
  v_bfe_u32 v11, v0, 2, 3
  v_mul_u32_u24 v13, 2064, v2
  v_lshl_add_u32 v13, v11, 5, v13
  v_lshl_add_u32 v13, v7, 3, v13
  v_add_u32 v13, 18432, v13
  ds_read_b64 v[16:17], v13 offset:0
  ds_read_b64 v[18:19], v13 offset:256
  ds_read_b64 v[20:21], v13 offset:512
  ds_read_b64 v[22:23], v13 offset:768
  ds_read_b64 v[24:25], v13 offset:1024
  ds_read_b64 v[26:27], v13 offset:1280
  ds_read_b64 v[28:29], v13 offset:1536
  ds_read_b64 v[30:31], v13 offset:1792
  v_mul_u32_u24 v9, 2304, v2
  v_lshl_add_u32 v10, v1, 3, v9
  v_mul_u32_u24 v12, 288, v11
  v_add_u32 v12, v12, v9
  v_lshl_add_u32 v12, v7, 3, v12
  s_waitcnt lgkmcnt(0)
  v_pk_mul_f32 v[32:33], v[18:19], v[94:95] op_sel:[0,0] op_sel_hi:[1,0]
  v_pk_fma_f32 v[18:19], v[18:19], v[94:95], v[32:33] op_sel:[1,1,0] op_sel_hi:[0,1,1] neg_hi:[0,1,0]
  v_pk_mul_f32 v[32:33], v[20:21], v[96:97] op_sel:[0,0] op_sel_hi:[1,0]
  v_pk_fma_f32 v[20:21], v[20:21], v[96:97], v[32:33] op_sel:[1,1,0] op_sel_hi:[0,1,1] neg_hi:[0,1,0]
  v_pk_mul_f32 v[32:33], v[22:23], v[98:99] op_sel:[0,0] op_sel_hi:[1,0]
  v_pk_fma_f32 v[22:23], v[22:23], v[98:99], v[32:33] op_sel:[1,1,0] op_sel_hi:[0,1,1] neg_hi:[0,1,0]
  v_pk_mul_f32 v[32:33], v[24:25], v[100:101] op_sel:[0,0] op_sel_hi:[1,0]
  v_pk_fma_f32 v[24:25], v[24:25], v[100:101], v[32:33] op_sel:[1,1,0] op_sel_hi:[0,1,1] neg_hi:[0,1,0]
  v_pk_mul_f32 v[32:33], v[26:27], v[102:103] op_sel:[0,0] op_sel_hi:[1,0]
  v_pk_fma_f32 v[26:27], v[26:27], v[102:103], v[32:33] op_sel:[1,1,0] op_sel_hi:[0,1,1] neg_hi:[0,1,0]
  v_pk_mul_f32 v[32:33], v[28:29], v[104:105] op_sel:[0,0] op_sel_hi:[1,0]
  v_pk_fma_f32 v[28:29], v[28:29], v[104:105], v[32:33] op_sel:[1,1,0] op_sel_hi:[0,1,1] neg_hi:[0,1,0]
  v_pk_mul_f32 v[32:33], v[30:31], v[106:107] op_sel:[0,0] op_sel_hi:[1,0]
  v_pk_fma_f32 v[30:31], v[30:31], v[106:107], v[32:33] op_sel:[1,1,0] op_sel_hi:[0,1,1] neg_hi:[0,1,0]
  v_pk_add_f32 v[32:33], v[16:17], v[24:25]
  v_pk_add_f32 v[24:25], v[16:17], v[24:25] neg_lo:[0,1] neg_hi:[0,1]
  v_pk_add_f32 v[34:35], v[18:19], v[26:27]
  v_pk_add_f32 v[26:27], v[18:19], v[26:27] neg_lo:[0,1] neg_hi:[0,1]
  v_pk_add_f32 v[36:37], v[20:21], v[28:29]
  v_pk_add_f32 v[28:29], v[20:21], v[28:29] neg_lo:[0,1] neg_hi:[0,1]
  v_pk_add_f32 v[38:39], v[22:23], v[30:31]
  v_pk_add_f32 v[30:31], v[22:23], v[30:31] neg_lo:[0,1] neg_hi:[0,1]
  v_pk_add_f32 v[16:17], v[32:33], v[36:37]
  v_pk_add_f32 v[18:19], v[32:33], v[36:37] neg_lo:[0,1] neg_hi:[0,1]
  v_pk_add_f32 v[20:21], v[34:35], v[38:39]
  v_pk_add_f32 v[22:23], v[34:35], v[38:39] neg_lo:[0,1] neg_hi:[0,1]
  v_pk_add_f32 v[32:33], v[16:17], v[20:21]
  v_pk_add_f32 v[34:35], v[16:17], v[20:21] neg_lo:[0,1] neg_hi:[0,1]
  v_pk_add_f32 v[36:37], v[18:19], v[22:23] op_sel:[0,1] op_sel_hi:[1,0] neg_lo:[0,1]
  v_pk_add_f32 v[38:39], v[18:19], v[22:23] op_sel:[0,1] op_sel_hi:[1,0] neg_hi:[0,1]
  v_pk_add_f32 v[16:17], v[24:25], v[28:29] op_sel:[0,1] op_sel_hi:[1,0] neg_lo:[0,1]
  v_pk_add_f32 v[18:19], v[24:25], v[28:29] op_sel:[0,1] op_sel_hi:[1,0] neg_hi:[0,1]
  v_pk_add_f32 v[20:21], v[26:27], v[26:27] op_sel:[0,1] op_sel_hi:[1,0] neg_lo:[0,1]
  v_pk_add_f32 v[22:23], v[30:31], v[30:31] op_sel:[0,1] op_sel_hi:[1,0] neg_hi:[0,1]
  v_pk_add_f32 v[24:25], v[20:21], v[22:23] neg_lo:[0,1] neg_hi:[0,1]
  v_pk_add_f32 v[26:27], v[20:21], v[22:23]
  v_pk_fma_f32 v[28:29], v[24:25], s[60:61], v[16:17]
  v_pk_fma_f32 v[30:31], v[24:25], s[60:61], v[16:17] neg_lo:[1,0,0] neg_hi:[1,0,0]
  v_pk_fma_f32 v[20:21], v[26:27], s[60:61], v[18:19] op_sel:[1,0,0] op_sel_hi:[0,1,1] neg_lo:[1,0,0]
  v_pk_fma_f32 v[22:23], v[26:27], s[60:61], v[18:19] op_sel:[1,0,0] op_sel_hi:[0,1,1] neg_hi:[1,0,0]
  ds_write_b64 v12, v[32:33] offset:0
  ds_write_b64 v12, v[28:29] offset:32
  ds_write_b64 v12, v[36:37] offset:64
  ds_write_b64 v12, v[20:21] offset:96
  ds_write_b64 v12, v[34:35] offset:128
  ds_write_b64 v12, v[30:31] offset:160
  ds_write_b64 v12, v[38:39] offset:192
  ds_write_b64 v12, v[22:23] offset:224
  ds_read_b64 v[32:33], v10 offset:0
  ds_read_b64 v[28:29], v10 offset:288
  ds_read_b64 v[36:37], v10 offset:576
  ds_read_b64 v[20:21], v10 offset:864
  ds_read_b64 v[34:35], v10 offset:1152
  ds_read_b64 v[30:31], v10 offset:1440
  ds_read_b64 v[38:39], v10 offset:1728
  ds_read_b64 v[22:23], v10 offset:2016
  s_waitcnt lgkmcnt(0)
  v_pk_mul_f32 v[16:17], v[28:29], v[80:81] op_sel:[0,0] op_sel_hi:[1,0]
  v_pk_fma_f32 v[28:29], v[28:29], v[80:81], v[16:17] op_sel:[1,1,0] op_sel_hi:[0,1,1] neg_hi:[0,1,0]
  v_pk_mul_f32 v[16:17], v[36:37], v[82:83] op_sel:[0,0] op_sel_hi:[1,0]
  v_pk_fma_f32 v[36:37], v[36:37], v[82:83], v[16:17] op_sel:[1,1,0] op_sel_hi:[0,1,1] neg_hi:[0,1,0]
  v_pk_mul_f32 v[16:17], v[20:21], v[84:85] op_sel:[0,0] op_sel_hi:[1,0]
  v_pk_fma_f32 v[20:21], v[20:21], v[84:85], v[16:17] op_sel:[1,1,0] op_sel_hi:[0,1,1] neg_hi:[0,1,0]
  v_pk_mul_f32 v[16:17], v[34:35], v[86:87] op_sel:[0,0] op_sel_hi:[1,0]
  v_pk_fma_f32 v[34:35], v[34:35], v[86:87], v[16:17] op_sel:[1,1,0] op_sel_hi:[0,1,1] neg_hi:[0,1,0]
  v_pk_mul_f32 v[16:17], v[30:31], v[88:89] op_sel:[0,0] op_sel_hi:[1,0]
  v_pk_fma_f32 v[30:31], v[30:31], v[88:89], v[16:17] op_sel:[1,1,0] op_sel_hi:[0,1,1] neg_hi:[0,1,0]
  v_pk_mul_f32 v[16:17], v[38:39], v[90:91] op_sel:[0,0] op_sel_hi:[1,0]
  v_pk_fma_f32 v[38:39], v[38:39], v[90:91], v[16:17] op_sel:[1,1,0] op_sel_hi:[0,1,1] neg_hi:[0,1,0]
  v_pk_mul_f32 v[16:17], v[22:23], v[92:93] op_sel:[0,0] op_sel_hi:[1,0]
  v_pk_fma_f32 v[22:23], v[22:23], v[92:93], v[16:17] op_sel:[1,1,0] op_sel_hi:[0,1,1] neg_hi:[0,1,0]
  v_pk_add_f32 v[16:17], v[32:33], v[34:35]
  v_pk_add_f32 v[34:35], v[32:33], v[34:35] neg_lo:[0,1] neg_hi:[0,1]
  v_pk_add_f32 v[18:19], v[28:29], v[30:31]
  v_pk_add_f32 v[30:31], v[28:29], v[30:31] neg_lo:[0,1] neg_hi:[0,1]
  v_pk_add_f32 v[24:25], v[36:37], v[38:39]
  v_pk_add_f32 v[38:39], v[36:37], v[38:39] neg_lo:[0,1] neg_hi:[0,1]
  v_pk_add_f32 v[26:27], v[20:21], v[22:23]
  v_pk_add_f32 v[22:23], v[20:21], v[22:23] neg_lo:[0,1] neg_hi:[0,1]
  v_pk_add_f32 v[32:33], v[16:17], v[24:25]
  v_pk_add_f32 v[28:29], v[16:17], v[24:25] neg_lo:[0,1] neg_hi:[0,1]
  v_pk_add_f32 v[36:37], v[18:19], v[26:27]
  v_pk_add_f32 v[20:21], v[18:19], v[26:27] neg_lo:[0,1] neg_hi:[0,1]
  v_pk_add_f32 v[16:17], v[32:33], v[36:37]
  v_pk_add_f32 v[18:19], v[32:33], v[36:37] neg_lo:[0,1] neg_hi:[0,1]
  v_pk_add_f32 v[24:25], v[28:29], v[20:21] op_sel:[0,1] op_sel_hi:[1,0] neg_lo:[0,1]
  v_pk_add_f32 v[26:27], v[28:29], v[20:21] op_sel:[0,1] op_sel_hi:[1,0] neg_hi:[0,1]
  v_pk_add_f32 v[32:33], v[34:35], v[38:39] op_sel:[0,1] op_sel_hi:[1,0] neg_lo:[0,1]
  v_pk_add_f32 v[28:29], v[34:35], v[38:39] op_sel:[0,1] op_sel_hi:[1,0] neg_hi:[0,1]
  v_pk_add_f32 v[36:37], v[30:31], v[30:31] op_sel:[0,1] op_sel_hi:[1,0] neg_lo:[0,1]
  v_pk_add_f32 v[20:21], v[22:23], v[22:23] op_sel:[0,1] op_sel_hi:[1,0] neg_hi:[0,1]
  v_pk_add_f32 v[34:35], v[36:37], v[20:21] neg_lo:[0,1] neg_hi:[0,1]
  v_pk_add_f32 v[30:31], v[36:37], v[20:21]
  v_pk_fma_f32 v[38:39], v[34:35], s[60:61], v[32:33]
  v_pk_fma_f32 v[22:23], v[34:35], s[60:61], v[32:33] neg_lo:[1,0,0] neg_hi:[1,0,0]
  v_pk_fma_f32 v[36:37], v[30:31], s[60:61], v[28:29] op_sel:[1,0,0] op_sel_hi:[0,1,1] neg_lo:[1,0,0]
  v_pk_fma_f32 v[20:21], v[30:31], s[60:61], v[28:29] op_sel:[1,0,0] op_sel_hi:[0,1,1] neg_hi:[1,0,0]
  s_mov_b32 s62, 0x35000000
  s_mov_b32 s63, 0x35000000
  v_mul_u32_u24 v13, 2304, v2
  v_lshl_add_u32 v13, v1, 2, v13
  v_pk_mul_f32 v[16:17], v[16:17], s[62:63]
  v_cvt_pk_bf16_f32 v124, v16, v17
  v_lshlrev_b32 v16, 16, v124
  v_and_b32 v17, 0xffff0000, v124
  v_pk_mul_f32 v[16:17], v[16:17], v[128:129]
  v_cvt_pk_bf16_f32 v124, v16, v17
  v_lshlrev_b32 v16, 16, v124
  v_and_b32 v17, 0xffff0000, v124
  v_lshlrev_b32 v126, 16, v40
  v_and_b32 v127, 0xffff0000, v40
  v_pk_add_f32 v[16:17], v[16:17], v[126:127]
  v_cvt_pk_bf16_f32 v124, v16, v17
  v_lshlrev_b32 v16, 16, v124
  v_and_b32 v17, 0xffff0000, v124
  ds_write_b32 v13, v124 offset:0
  v_pk_mul_f32 v[38:39], v[38:39], s[62:63]
  v_cvt_pk_bf16_f32 v124, v38, v39
  v_lshlrev_b32 v38, 16, v124
  v_and_b32 v39, 0xffff0000, v124
  v_pk_mul_f32 v[38:39], v[38:39], v[130:131]
  v_cvt_pk_bf16_f32 v124, v38, v39
  v_lshlrev_b32 v38, 16, v124
  v_and_b32 v39, 0xffff0000, v124
  v_lshlrev_b32 v126, 16, v41
  v_and_b32 v127, 0xffff0000, v41
  v_pk_add_f32 v[38:39], v[38:39], v[126:127]
  v_cvt_pk_bf16_f32 v124, v38, v39
  v_lshlrev_b32 v38, 16, v124
  v_and_b32 v39, 0xffff0000, v124
  ds_write_b32 v13, v124 offset:128
  v_pk_mul_f32 v[24:25], v[24:25], s[62:63]
  v_cvt_pk_bf16_f32 v124, v24, v25
  v_lshlrev_b32 v24, 16, v124
  v_and_b32 v25, 0xffff0000, v124
  v_pk_mul_f32 v[24:25], v[24:25], v[132:133]
  v_cvt_pk_bf16_f32 v124, v24, v25
  v_lshlrev_b32 v24, 16, v124
  v_and_b32 v25, 0xffff0000, v124
  v_lshlrev_b32 v126, 16, v42
  v_and_b32 v127, 0xffff0000, v42
  v_pk_add_f32 v[24:25], v[24:25], v[126:127]
  v_cvt_pk_bf16_f32 v124, v24, v25
  v_lshlrev_b32 v24, 16, v124
  v_and_b32 v25, 0xffff0000, v124
  ds_write_b32 v13, v124 offset:256
  v_pk_mul_f32 v[36:37], v[36:37], s[62:63]
  v_cvt_pk_bf16_f32 v124, v36, v37
  v_lshlrev_b32 v36, 16, v124
  v_and_b32 v37, 0xffff0000, v124
  v_pk_mul_f32 v[36:37], v[36:37], v[134:135]
  v_cvt_pk_bf16_f32 v124, v36, v37
  v_lshlrev_b32 v36, 16, v124
  v_and_b32 v37, 0xffff0000, v124
  v_lshlrev_b32 v126, 16, v43
  v_and_b32 v127, 0xffff0000, v43
  v_pk_add_f32 v[36:37], v[36:37], v[126:127]
  v_cvt_pk_bf16_f32 v124, v36, v37
  v_lshlrev_b32 v36, 16, v124
  v_and_b32 v37, 0xffff0000, v124
  ds_write_b32 v13, v124 offset:384
  v_pk_mul_f32 v[18:19], v[18:19], s[62:63]
  v_cvt_pk_bf16_f32 v124, v18, v19
  v_lshlrev_b32 v18, 16, v124
  v_and_b32 v19, 0xffff0000, v124
  v_pk_mul_f32 v[18:19], v[18:19], v[136:137]
  v_cvt_pk_bf16_f32 v124, v18, v19
  v_lshlrev_b32 v18, 16, v124
  v_and_b32 v19, 0xffff0000, v124
  v_lshlrev_b32 v126, 16, v44
  v_and_b32 v127, 0xffff0000, v44
  v_pk_add_f32 v[18:19], v[18:19], v[126:127]
  v_cvt_pk_bf16_f32 v124, v18, v19
  v_lshlrev_b32 v18, 16, v124
  v_and_b32 v19, 0xffff0000, v124
  ds_write_b32 v13, v124 offset:512
  v_pk_mul_f32 v[22:23], v[22:23], s[62:63]
  v_cvt_pk_bf16_f32 v124, v22, v23
  v_lshlrev_b32 v22, 16, v124
  v_and_b32 v23, 0xffff0000, v124
  v_pk_mul_f32 v[22:23], v[22:23], v[138:139]
  v_cvt_pk_bf16_f32 v124, v22, v23
  v_lshlrev_b32 v22, 16, v124
  v_and_b32 v23, 0xffff0000, v124
  v_lshlrev_b32 v126, 16, v45
  v_and_b32 v127, 0xffff0000, v45
  v_pk_add_f32 v[22:23], v[22:23], v[126:127]
  v_cvt_pk_bf16_f32 v124, v22, v23
  v_lshlrev_b32 v22, 16, v124
  v_and_b32 v23, 0xffff0000, v124
  ds_write_b32 v13, v124 offset:640
  v_pk_mul_f32 v[26:27], v[26:27], s[62:63]
  v_cvt_pk_bf16_f32 v124, v26, v27
  v_lshlrev_b32 v26, 16, v124
  v_and_b32 v27, 0xffff0000, v124
  v_pk_mul_f32 v[26:27], v[26:27], v[140:141]
  v_cvt_pk_bf16_f32 v124, v26, v27
  v_lshlrev_b32 v26, 16, v124
  v_and_b32 v27, 0xffff0000, v124
  v_lshlrev_b32 v126, 16, v46
  v_and_b32 v127, 0xffff0000, v46
  v_pk_add_f32 v[26:27], v[26:27], v[126:127]
  v_cvt_pk_bf16_f32 v124, v26, v27
  v_lshlrev_b32 v26, 16, v124
  v_and_b32 v27, 0xffff0000, v124
  ds_write_b32 v13, v124 offset:768
  v_pk_mul_f32 v[20:21], v[20:21], s[62:63]
  v_cvt_pk_bf16_f32 v124, v20, v21
  v_lshlrev_b32 v20, 16, v124
  v_and_b32 v21, 0xffff0000, v124
  v_pk_mul_f32 v[20:21], v[20:21], v[142:143]
  v_cvt_pk_bf16_f32 v124, v20, v21
  v_lshlrev_b32 v20, 16, v124
  v_and_b32 v21, 0xffff0000, v124
  v_lshlrev_b32 v126, 16, v47
  v_and_b32 v127, 0xffff0000, v47
  v_pk_add_f32 v[20:21], v[20:21], v[126:127]
  v_cvt_pk_bf16_f32 v124, v20, v21
  v_lshlrev_b32 v20, 16, v124
  v_and_b32 v21, 0xffff0000, v124
  ds_write_b32 v13, v124 offset:896
  v_pk_add_f32 v[124:125], v[16:17], v[38:39]
  v_pk_add_f32 v[124:125], v[124:125], v[24:25]
  v_pk_add_f32 v[124:125], v[124:125], v[36:37]
  v_pk_add_f32 v[124:125], v[124:125], v[18:19]
  v_pk_add_f32 v[124:125], v[124:125], v[22:23]
  v_pk_add_f32 v[124:125], v[124:125], v[26:27]
  v_pk_add_f32 v[124:125], v[124:125], v[20:21]
  v_add_f32 v120, v124, v125
  s_nop 1
  v_add_f32_dpp v120, v120, v120 quad_perm:[1,0,3,2] row_mask:0xf bank_mask:0xf
  s_nop 1
  v_add_f32_dpp v120, v120, v120 quad_perm:[2,3,0,1] row_mask:0xf bank_mask:0xf
  s_nop 1
  v_add_f32_dpp v120, v120, v120 row_half_mirror row_mask:0xf bank_mask:0xf
  s_nop 1
  v_add_f32_dpp v120, v120, v120 row_mirror row_mask:0xf bank_mask:0xf
  v_mov_b32 v121, v120
  s_nop 1
  v_permlane16_swap_b32 v120, v121
  s_nop 1
  v_add_f32 v120, v120, v121
  v_mul_f32 v120, 0x3b000000, v120
  v_mov_b32 v121, v120
  v_mov_b32 v122, 0
  v_mov_b32 v123, 0
  v_pk_add_f32 v[124:125], v[16:17], v[120:121] neg_lo:[0,1] neg_hi:[0,1]
  v_pk_fma_f32 v[122:123], v[124:125], v[124:125], v[122:123]
  v_pk_add_f32 v[124:125], v[38:39], v[120:121] neg_lo:[0,1] neg_hi:[0,1]
  v_pk_fma_f32 v[122:123], v[124:125], v[124:125], v[122:123]
  v_pk_add_f32 v[124:125], v[24:25], v[120:121] neg_lo:[0,1] neg_hi:[0,1]
  v_pk_fma_f32 v[122:123], v[124:125], v[124:125], v[122:123]
  v_pk_add_f32 v[124:125], v[36:37], v[120:121] neg_lo:[0,1] neg_hi:[0,1]
  v_pk_fma_f32 v[122:123], v[124:125], v[124:125], v[122:123]
  v_pk_add_f32 v[124:125], v[18:19], v[120:121] neg_lo:[0,1] neg_hi:[0,1]
  v_pk_fma_f32 v[122:123], v[124:125], v[124:125], v[122:123]
  v_pk_add_f32 v[124:125], v[22:23], v[120:121] neg_lo:[0,1] neg_hi:[0,1]
  v_pk_fma_f32 v[122:123], v[124:125], v[124:125], v[122:123]
  v_pk_add_f32 v[124:125], v[26:27], v[120:121] neg_lo:[0,1] neg_hi:[0,1]
  v_pk_fma_f32 v[122:123], v[124:125], v[124:125], v[122:123]
  v_pk_add_f32 v[124:125], v[20:21], v[120:121] neg_lo:[0,1] neg_hi:[0,1]
  v_pk_fma_f32 v[122:123], v[124:125], v[124:125], v[122:123]
  v_add_f32 v122, v122, v123
  s_nop 1
  v_add_f32_dpp v122, v122, v122 quad_perm:[1,0,3,2] row_mask:0xf bank_mask:0xf
  s_nop 1
  v_add_f32_dpp v122, v122, v122 quad_perm:[2,3,0,1] row_mask:0xf bank_mask:0xf
  s_nop 1
  v_add_f32_dpp v122, v122, v122 row_half_mirror row_mask:0xf bank_mask:0xf
  s_nop 1
  v_add_f32_dpp v122, v122, v122 row_mirror row_mask:0xf bank_mask:0xf
  v_mov_b32 v123, v122
  s_nop 1
  v_permlane16_swap_b32 v122, v123
  s_nop 1
  v_add_f32 v122, v122, v123
  v_mul_f32 v122, 0x3b000000, v122
  v_cvt_pk_bf16_f32 v122, v122, v122
  v_lshlrev_b32 v122, 16, v122
  v_add_f32 v122, 0x3727c5ac, v122
  v_cvt_pk_bf16_f32 v122, v122, v122
  v_lshlrev_b32 v122, 16, v122
  v_sqrt_f32 v122, v122
  s_nop 0
  v_cvt_pk_bf16_f32 v122, v122, v122
  v_lshlrev_b32 v122, 16, v122
  v_rcp_f32 v122, v122
  v_cvt_pk_bf16_f32 v120, v120, v120
  v_lshlrev_b32 v120, 16, v120
  v_mov_b32 v121, v120
  v_mov_b32 v123, v122
  v_pk_add_f32 v[16:17], v[16:17], v[120:121] neg_lo:[0,1] neg_hi:[0,1]
  v_cvt_pk_bf16_f32 v124, v16, v17
  v_lshlrev_b32 v16, 16, v124
  v_and_b32 v17, 0xffff0000, v124
  v_pk_mul_f32 v[16:17], v[16:17], v[122:123]
  v_cvt_pk_bf16_f32 v124, v16, v17
  v_lshlrev_b32 v16, 16, v124
  v_and_b32 v17, 0xffff0000, v124
  v_pk_mul_f32 v[16:17], v[16:17], v[48:49]
  v_cvt_pk_bf16_f32 v124, v16, v17
  v_lshlrev_b32 v16, 16, v124
  v_and_b32 v17, 0xffff0000, v124
  v_pk_add_f32 v[16:17], v[16:17], v[64:65]
  v_cvt_pk_bf16_f32 v124, v16, v17
  v_lshlrev_b32 v16, 16, v124
  v_and_b32 v17, 0xffff0000, v124
  v_pk_add_f32 v[38:39], v[38:39], v[120:121] neg_lo:[0,1] neg_hi:[0,1]
  v_cvt_pk_bf16_f32 v124, v38, v39
  v_lshlrev_b32 v38, 16, v124
  v_and_b32 v39, 0xffff0000, v124
  v_pk_mul_f32 v[38:39], v[38:39], v[122:123]
  v_cvt_pk_bf16_f32 v124, v38, v39
  v_lshlrev_b32 v38, 16, v124
  v_and_b32 v39, 0xffff0000, v124
  v_pk_mul_f32 v[38:39], v[38:39], v[50:51]
  v_cvt_pk_bf16_f32 v124, v38, v39
  v_lshlrev_b32 v38, 16, v124
  v_and_b32 v39, 0xffff0000, v124
  v_pk_add_f32 v[38:39], v[38:39], v[66:67]
  v_cvt_pk_bf16_f32 v124, v38, v39
  v_lshlrev_b32 v38, 16, v124
  v_and_b32 v39, 0xffff0000, v124
  v_pk_add_f32 v[24:25], v[24:25], v[120:121] neg_lo:[0,1] neg_hi:[0,1]
  v_cvt_pk_bf16_f32 v124, v24, v25
  v_lshlrev_b32 v24, 16, v124
  v_and_b32 v25, 0xffff0000, v124
  v_pk_mul_f32 v[24:25], v[24:25], v[122:123]
  v_cvt_pk_bf16_f32 v124, v24, v25
  v_lshlrev_b32 v24, 16, v124
  v_and_b32 v25, 0xffff0000, v124
  v_pk_mul_f32 v[24:25], v[24:25], v[52:53]
  v_cvt_pk_bf16_f32 v124, v24, v25
  v_lshlrev_b32 v24, 16, v124
  v_and_b32 v25, 0xffff0000, v124
  v_pk_add_f32 v[24:25], v[24:25], v[68:69]
  v_cvt_pk_bf16_f32 v124, v24, v25
  v_lshlrev_b32 v24, 16, v124
  v_and_b32 v25, 0xffff0000, v124
  v_pk_add_f32 v[36:37], v[36:37], v[120:121] neg_lo:[0,1] neg_hi:[0,1]
  v_cvt_pk_bf16_f32 v124, v36, v37
  v_lshlrev_b32 v36, 16, v124
  v_and_b32 v37, 0xffff0000, v124
  v_pk_mul_f32 v[36:37], v[36:37], v[122:123]
  v_cvt_pk_bf16_f32 v124, v36, v37
  v_lshlrev_b32 v36, 16, v124
  v_and_b32 v37, 0xffff0000, v124
  v_pk_mul_f32 v[36:37], v[36:37], v[54:55]
  v_cvt_pk_bf16_f32 v124, v36, v37
  v_lshlrev_b32 v36, 16, v124
  v_and_b32 v37, 0xffff0000, v124
  v_pk_add_f32 v[36:37], v[36:37], v[70:71]
  v_cvt_pk_bf16_f32 v124, v36, v37
  v_lshlrev_b32 v36, 16, v124
  v_and_b32 v37, 0xffff0000, v124
  v_pk_add_f32 v[18:19], v[18:19], v[120:121] neg_lo:[0,1] neg_hi:[0,1]
  v_cvt_pk_bf16_f32 v124, v18, v19
  v_lshlrev_b32 v18, 16, v124
  v_and_b32 v19, 0xffff0000, v124
  v_pk_mul_f32 v[18:19], v[18:19], v[122:123]
  v_cvt_pk_bf16_f32 v124, v18, v19
  v_lshlrev_b32 v18, 16, v124
  v_and_b32 v19, 0xffff0000, v124
  v_pk_mul_f32 v[18:19], v[18:19], v[56:57]
  v_cvt_pk_bf16_f32 v124, v18, v19
  v_lshlrev_b32 v18, 16, v124
  v_and_b32 v19, 0xffff0000, v124
  v_pk_add_f32 v[18:19], v[18:19], v[72:73]
  v_cvt_pk_bf16_f32 v124, v18, v19
  v_lshlrev_b32 v18, 16, v124
  v_and_b32 v19, 0xffff0000, v124
  v_pk_add_f32 v[22:23], v[22:23], v[120:121] neg_lo:[0,1] neg_hi:[0,1]
  v_cvt_pk_bf16_f32 v124, v22, v23
  v_lshlrev_b32 v22, 16, v124
  v_and_b32 v23, 0xffff0000, v124
  v_pk_mul_f32 v[22:23], v[22:23], v[122:123]
  v_cvt_pk_bf16_f32 v124, v22, v23
  v_lshlrev_b32 v22, 16, v124
  v_and_b32 v23, 0xffff0000, v124
  v_pk_mul_f32 v[22:23], v[22:23], v[58:59]
  v_cvt_pk_bf16_f32 v124, v22, v23
  v_lshlrev_b32 v22, 16, v124
  v_and_b32 v23, 0xffff0000, v124
  v_pk_add_f32 v[22:23], v[22:23], v[74:75]
  v_cvt_pk_bf16_f32 v124, v22, v23
  v_lshlrev_b32 v22, 16, v124
  v_and_b32 v23, 0xffff0000, v124
  v_pk_add_f32 v[26:27], v[26:27], v[120:121] neg_lo:[0,1] neg_hi:[0,1]
  v_cvt_pk_bf16_f32 v124, v26, v27
  v_lshlrev_b32 v26, 16, v124
  v_and_b32 v27, 0xffff0000, v124
  v_pk_mul_f32 v[26:27], v[26:27], v[122:123]
  v_cvt_pk_bf16_f32 v124, v26, v27
  v_lshlrev_b32 v26, 16, v124
  v_and_b32 v27, 0xffff0000, v124
  v_pk_mul_f32 v[26:27], v[26:27], v[60:61]
  v_cvt_pk_bf16_f32 v124, v26, v27
  v_lshlrev_b32 v26, 16, v124
  v_and_b32 v27, 0xffff0000, v124
  v_pk_add_f32 v[26:27], v[26:27], v[76:77]
  v_cvt_pk_bf16_f32 v124, v26, v27
  v_lshlrev_b32 v26, 16, v124
  v_and_b32 v27, 0xffff0000, v124
  v_pk_add_f32 v[20:21], v[20:21], v[120:121] neg_lo:[0,1] neg_hi:[0,1]
  v_cvt_pk_bf16_f32 v124, v20, v21
  v_lshlrev_b32 v20, 16, v124
  v_and_b32 v21, 0xffff0000, v124
  v_pk_mul_f32 v[20:21], v[20:21], v[122:123]
  v_cvt_pk_bf16_f32 v124, v20, v21
  v_lshlrev_b32 v20, 16, v124
  v_and_b32 v21, 0xffff0000, v124
  v_pk_mul_f32 v[20:21], v[20:21], v[62:63]
  v_cvt_pk_bf16_f32 v124, v20, v21
  v_lshlrev_b32 v20, 16, v124
  v_and_b32 v21, 0xffff0000, v124
  v_pk_add_f32 v[20:21], v[20:21], v[78:79]
  v_cvt_pk_bf16_f32 v124, v20, v21
  v_lshlrev_b32 v20, 16, v124
  v_and_b32 v21, 0xffff0000, v124
  v_cvt_pk_bf16_f32 v40, v16, v17
  ds_write_b32 v13, v40 offset:1040
  v_cvt_pk_bf16_f32 v41, v38, v39
  ds_write_b32 v13, v41 offset:1168
  v_cvt_pk_bf16_f32 v42, v24, v25
  ds_write_b32 v13, v42 offset:1296
  v_cvt_pk_bf16_f32 v43, v36, v37
  ds_write_b32 v13, v43 offset:1424
  v_cvt_pk_bf16_f32 v44, v18, v19
  ds_write_b32 v13, v44 offset:1552
  v_cvt_pk_bf16_f32 v45, v22, v23
  ds_write_b32 v13, v45 offset:1680
  v_cvt_pk_bf16_f32 v46, v26, v27
  ds_write_b32 v13, v46 offset:1808
  v_cvt_pk_bf16_f32 v47, v20, v21
  ds_write_b32 v13, v47 offset:1936
  s_waitcnt lgkmcnt(0)
  s_barrier
  v_and_b32 v14, 7, v0
  v_lshrrev_b32 v8, 3, v0
  v_mul_u32_u24 v13, 2304, v14
  v_lshl_add_u32 v13, v8, 4, v13
  ds_read_b128 v[16:19], v13
  ds_read_b128 v[20:23], v13 offset:512
  ds_read_b128 v[24:27], v13 offset:1040
  ds_read_b128 v[28:31], v13 offset:1552
  s_lshl_b32 s3, s71, 13
  v_lshl_add_u32 v10, v14, 10, s3
  v_lshl_add_u32 v10, v8, 4, v10
  s_lshr_b32 s3, s71, 1
  s_lshl_b32 s3, s3, 14
  s_and_b32 s47, s71, 1
  s_lshl_b32 s47, s47, 7
  s_add_u32 s3, s3, s47
  v_lshl_add_u32 v11, v8, 8, s3
  v_lshl_add_u32 v11, v14, 4, v11
  s_movk_i32 s47, 8192
  s_waitcnt lgkmcnt(0)
  s_cmp_eq_u32 s69, 1
  s_cbranch_scc1 sdf_0
  buffer_store_dwordx4 v[16:19], v10, s[20:23], 0 offen sc1
  s_branch sde_0
sdf_0:
  buffer_store_dwordx4 v[16:19], v10, s[20:23], 0 offen
sde_0:
  s_cmp_eq_u32 s69, 1
  s_cbranch_scc1 sdf_1
  buffer_store_dwordx4 v[20:23], v10, s[20:23], 0 offen offset:512 sc1
  s_branch sde_1
sdf_1:
  buffer_store_dwordx4 v[20:23], v10, s[20:23], 0 offen offset:512
sde_1:
  s_cmp_eq_u32 s69, 1
  s_cbranch_scc1 sdf_2
  buffer_store_dwordx4 v[24:27], v11, s[24:27], 0 offen sc1
  s_branch sde_2
sdf_2:
  buffer_store_dwordx4 v[24:27], v11, s[24:27], 0 offen
sde_2:
  s_cmp_eq_u32 s69, 1
  s_cbranch_scc1 sdf_3
  buffer_store_dwordx4 v[28:31], v11, s[24:27], s47 offen sc1
  s_branch sde_3
sdf_3:
  buffer_store_dwordx4 v[28:31], v11, s[24:27], s47 offen
sde_3:
  s_waitcnt vmcnt(0) lgkmcnt(0)
  s_barrier
  s_cmp_lg_u32 s95, 0
  s_cbranch_scc1 arr_skip_d
  s_mov_b64 s[92:93], exec
  s_mov_b64 exec, 1
  s_lshl_b32 s94, s71, 6
  v_mov_b32 v255, s94
  v_mov_b32 v254, 4
  s_cmp_eq_u32 s69, 1
  s_cbranch_scc1 sdf_4
  buffer_store_dword v254, v255, s[64:67], 0 offen sc1
  s_branch sde_4
sdf_4:
  buffer_store_dword v254, v255, s[64:67], 0 offen
sde_4:
  s_mov_b64 exec, s[92:93]
arr_skip_d:
  s_branch join
helper:
  v_subrev_u32 v0, 256, v0
  s_cmp_ge_u32 s2, 16
  s_cbranch_scc1 h_nopf
  s_mov_b32 s8, s86
  s_mov_b32 s9, s87
  s_mov_b32 s10, k_done-adaLN_cond__spectral_gfnet__dense_activation_silu__prompt_kernel-4
  s_mov_b32 s11, 0x00020000
  v_lshlrev_b32 v1, 4, v0
  s_mov_b32 s12, 0
  buffer_load_dwordx4 v[16:19], v1, s[8:11], s12 offen
  s_add_u32 s12, s12, 4096
  buffer_load_dwordx4 v[20:23], v1, s[8:11], s12 offen
  s_add_u32 s12, s12, 4096
  buffer_load_dwordx4 v[24:27], v1, s[8:11], s12 offen
  s_add_u32 s12, s12, 4096
  buffer_load_dwordx4 v[28:31], v1, s[8:11], s12 offen
  s_add_u32 s12, s12, 4096
  buffer_load_dwordx4 v[32:35], v1, s[8:11], s12 offen
  s_add_u32 s12, s12, 4096
  buffer_load_dwordx4 v[36:39], v1, s[8:11], s12 offen
  s_add_u32 s12, s12, 4096
  buffer_load_dwordx4 v[40:43], v1, s[8:11], s12 offen
  s_add_u32 s12, s12, 4096
  buffer_load_dwordx4 v[44:47], v1, s[8:11], s12 offen
  s_add_u32 s12, s12, 4096
  buffer_load_dwordx4 v[48:51], v1, s[8:11], s12 offen
  s_add_u32 s12, s12, 4096
  buffer_load_dwordx4 v[52:55], v1, s[8:11], s12 offen
  s_add_u32 s12, s12, 4096
  buffer_load_dwordx4 v[56:59], v1, s[8:11], s12 offen
  s_add_u32 s12, s12, 4096
  buffer_load_dwordx4 v[60:63], v1, s[8:11], s12 offen
  s_add_u32 s12, s12, 4096
  buffer_load_dwordx4 v[64:67], v1, s[8:11], s12 offen
  s_add_u32 s12, s12, 4096
  buffer_load_dwordx4 v[68:71], v1, s[8:11], s12 offen
  s_add_u32 s12, s12, 4096
  buffer_load_dwordx4 v[72:75], v1, s[8:11], s12 offen
  s_add_u32 s12, s12, 4096
  buffer_load_dwordx4 v[76:79], v1, s[8:11], s12 offen
  s_add_u32 s12, s12, 4096
  buffer_load_dwordx4 v[80:83], v1, s[8:11], s12 offen
  s_add_u32 s12, s12, 4096
  buffer_load_dwordx4 v[84:87], v1, s[8:11], s12 offen
  s_add_u32 s12, s12, 4096
  buffer_load_dwordx4 v[88:91], v1, s[8:11], s12 offen
  s_add_u32 s12, s12, 4096
  buffer_load_dwordx4 v[92:95], v1, s[8:11], s12 offen
  s_add_u32 s12, s12, 4096
h_nopf:
  s_cmp_lt_u32 s2, 48
  s_cbranch_scc1 h_nowt
  s_cmp_ge_u32 s2, 96
  s_cbranch_scc1 h_nowt
  s_add_u32 s70, s2, 160
  s_load_dwordx4 s[8:11], s[0:1], 8
  s_waitcnt lgkmcnt(0)
  s_mov_b32 s12, s8
  s_mov_b32 s13, s9
  s_mov_b32 s14, 0x101000
  s_mov_b32 s15, 0x00020000
  s_mov_b32 s16, s10
  s_mov_b32 s17, s11
  s_mov_b32 s18, 0x101000
  s_mov_b32 s19, 0x00020000
  s_add_u32 s20, s4, 0x10000
  s_addc_u32 s21, s5, 0
  s_mov_b32 s22, 0x200000
  s_mov_b32 s23, 0x00020000
  s_and_b32 s25, s70, 7
  s_lshr_b32 s26, s70, 3
  s_and_b32 s27, s26, 7
  s_lshr_b32 s26, s26, 3
  v_and_b32 v1, 63, v0
  s_lshl_b32 s28, s26, 6
  v_add_u32 v1, s28, v1
  v_lshrrev_b32 v2, 6, v0
  s_lshr_b32 s29, s25, 1
  s_lshl_b32 s29, s29, 9
  s_and_b32 s32, s25, 1
  s_lshl_b32 s32, s32, 6
  s_add_u32 s29, s29, s32
  s_add_u32 s29, s29, s27
  v_lshl_add_u32 v3, v2, 3, s29
  s_movk_i32 s33, 514
  v_mul_lo_u32 v3, v3, s33
  v_lshl_add_u32 v3, v1, 1, v3
  s_mov_b32 s34, 0
  buffer_load_ushort v8, v3, s[12:15], s34 offen
  buffer_load_ushort v12, v3, s[16:19], s34 offen
  s_mov_b32 s34, 65792
  buffer_load_ushort v9, v3, s[12:15], s34 offen
  buffer_load_ushort v13, v3, s[16:19], s34 offen
  s_mov_b32 s34, 131584
  buffer_load_ushort v10, v3, s[12:15], s34 offen
  buffer_load_ushort v14, v3, s[16:19], s34 offen
  s_mov_b32 s34, 197376
  buffer_load_ushort v11, v3, s[12:15], s34 offen
  buffer_load_ushort v15, v3, s[16:19], s34 offen
  s_mov_b32 s34, 16448
  buffer_load_ushort v16, v3, s[12:15], s34 offen
  buffer_load_ushort v20, v3, s[16:19], s34 offen
  s_mov_b32 s34, 82240
  buffer_load_ushort v17, v3, s[12:15], s34 offen
  buffer_load_ushort v21, v3, s[16:19], s34 offen
  s_mov_b32 s34, 148032
  buffer_load_ushort v18, v3, s[12:15], s34 offen
  buffer_load_ushort v22, v3, s[16:19], s34 offen
  s_mov_b32 s34, 213824
  buffer_load_ushort v19, v3, s[12:15], s34 offen
  buffer_load_ushort v23, v3, s[16:19], s34 offen
  v_lshlrev_b32 v4, 13, v1
  s_lshl_b32 s35, s25, 10
  s_lshl_b32 s36, s27, 7
  s_add_u32 s35, s35, s36
  v_add_u32 v4, s35, v4
  v_lshl_add_u32 v4, v2, 4, v4
  s_waitcnt vmcnt(0)
  v_lshl_or_b32 v8, v12, 16, v8
  v_lshl_or_b32 v9, v13, 16, v9
  v_lshl_or_b32 v10, v14, 16, v10
  v_lshl_or_b32 v11, v15, 16, v11
  v_lshl_or_b32 v16, v20, 16, v16
  v_lshl_or_b32 v17, v21, 16, v17
  v_lshl_or_b32 v18, v22, 16, v18
  v_lshl_or_b32 v19, v23, 16, v19
  buffer_store_dwordx4 v[8:11], v4, s[20:23], 0 offen sc1
  buffer_store_dwordx4 v[16:19], v4, s[20:23], 0 offen offset:64 sc1
h_nowt:
  s_cmp_lt_u32 s2, 248
  s_cbranch_scc1 wab_end
  s_load_dwordx4 s[8:11], s[0:1], 8
  s_waitcnt lgkmcnt(0)
  s_mov_b32 s12, s8
  s_mov_b32 s13, s9
  s_mov_b32 s14, 0x101000
  s_mov_b32 s15, 0x00020000
  s_mov_b32 s16, s10
  s_mov_b32 s17, s11
  s_mov_b32 s18, 0x101000
  s_mov_b32 s19, 0x00020000
  s_add_u32 s20, s4, 0x4000
  s_addc_u32 s21, s5, 0
  s_mov_b32 s22, 0x8000
  s_mov_b32 s23, 0x00020000
  s_sub_u32 s24, s2, 248
  s_lshr_b32 s25, s24, 1
  s_lshl_b32 s25, s25, 9
  s_and_b32 s26, s24, 1
  s_lshl_b32 s26, s26, 6
  s_add_u32 s25, s25, s26
  v_lshrrev_b32 v1, 5, v0
  v_bfe_u32 v2, v0, 2, 3
  v_and_b32 v3, 3, v0
  v_lshl_add_u32 v4, v2, 3, v1
  v_lshl_add_u32 v4, v3, 7, v4
  s_movk_i32 s33, 514
  v_lshlrev_b32 v9, 4, v0
  v_add_u32 v5, s25, v4
  v_sub_u32 v6, 2048, v5
  v_and_b32 v6, 2047, v6
  v_mul_lo_u32 v7, v5, s33
  v_mul_lo_u32 v8, v6, s33
  buffer_load_ushort v16, v7, s[12:15], 0 offen
  buffer_load_ushort v17, v7, s[16:19], 0 offen
  buffer_load_ushort v18, v7, s[12:15], 0 offen offset:512
  buffer_load_ushort v19, v7, s[16:19], 0 offen offset:512
  buffer_load_ushort v20, v8, s[12:15], 0 offen
  buffer_load_ushort v21, v8, s[16:19], 0 offen
  buffer_load_ushort v22, v8, s[12:15], 0 offen offset:512
  buffer_load_ushort v23, v8, s[16:19], 0 offen offset:512
  s_lshl_b32 s37, s24, 12
  s_waitcnt vmcnt(0)
  v_lshlrev_b32 v16, 16, v16
  v_lshlrev_b32 v17, 16, v17
  v_lshlrev_b32 v18, 16, v18
  v_lshlrev_b32 v19, 16, v19
  v_lshlrev_b32 v20, 16, v20
  v_lshlrev_b32 v21, 16, v21
  v_lshlrev_b32 v22, 16, v22
  v_lshlrev_b32 v23, 16, v23
  v_add_f32 v24, v16, v20
  v_sub_f32 v25, v17, v21
  v_add_f32 v26, v18, v22
  v_sub_f32 v27, v19, v23
  v_add_f32 v28, v24, v26
  v_add_f32 v29, v25, v27
  v_sub_f32 v30, v24, v26
  v_sub_f32 v31, v25, v27
  v_mul_f32 v28, 0.25, v28
  v_mul_f32 v29, 0.25, v29
  v_mul_f32 v30, 0.25, v30
  v_mul_f32 v31, 0.25, v31
  buffer_store_dwordx4 v[28:31], v9, s[20:23], s37 offen sc1
wab_end:
  s_barrier
  s_barrier
  s_waitcnt vmcnt(0)
  s_barrier
  s_load_dwordx2 s[8:9], s[0:1], 32
  s_waitcnt lgkmcnt(0)
  s_mov_b32 s12, s8
  s_mov_b32 s13, s9
  s_mov_b32 s14, 0x1c0000
  s_mov_b32 s15, 0x00020000
  s_add_u32 s16, s4, 0x210000
  s_addc_u32 s17, s5, 0
  s_mov_b32 s18, 0x1c0000
  s_mov_b32 s19, 0x00020000
  s_and_b32 s25, s2, 15
  s_lshr_b32 s26, s2, 4
  s_movk_i32 s27, 224
  v_cmp_gt_u32 vcc, s27, v0
  s_and_saveexec_b64 s[28:29], vcc
  s_cbranch_execz w1_end
  v_and_b32 v1, 7, v0
  v_bfe_u32 v2, v0, 3, 2
  v_lshrrev_b32 v3, 5, v0
  s_lshl_b32 s27, s26, 5
  v_lshl_add_u32 v4, v2, 3, s27
  s_movk_i32 s30, 3584
  v_mul_lo_u32 v4, v4, s30
  s_mul_i32 s31, s25, 224
  v_lshl_add_u32 v5, v3, 5, s31
  v_lshl_add_u32 v5, v1, 2, v5
  v_add_u32 v4, v4, v5
  s_mov_b32 s32, 0
  buffer_load_dword v8, v4, s[12:15], s32 offen
  s_add_u32 s32, s32, 3584
  buffer_load_dword v9, v4, s[12:15], s32 offen
  s_add_u32 s32, s32, 3584
  buffer_load_dword v10, v4, s[12:15], s32 offen
  s_add_u32 s32, s32, 3584
  buffer_load_dword v11, v4, s[12:15], s32 offen
  s_add_u32 s32, s32, 3584
  buffer_load_dword v12, v4, s[12:15], s32 offen
  s_add_u32 s32, s32, 3584
  buffer_load_dword v13, v4, s[12:15], s32 offen
  s_add_u32 s32, s32, 3584
  buffer_load_dword v14, v4, s[12:15], s32 offen
  s_add_u32 s32, s32, 3584
  buffer_load_dword v15, v4, s[12:15], s32 offen
  s_add_u32 s32, s32, 3584
  s_lshl_b32 s33, s25, 4
  s_add_u32 s33, s33, s26
  s_mul_i32 s33, s33, 7168
  v_lshl_add_u32 v6, v3, 10, s33
  v_lshl_add_u32 v6, v2, 8, v6
  v_lshl_add_u32 v6, v1, 5, v6
  s_mov_b32 s34, 0x05040100
  s_mov_b32 s35, 0x07060302
  s_waitcnt vmcnt(0)
  v_perm_b32 v16, v9, v8, s34
  v_perm_b32 v20, v9, v8, s35
  v_perm_b32 v17, v11, v10, s34
  v_perm_b32 v21, v11, v10, s35
  v_perm_b32 v18, v13, v12, s34
  v_perm_b32 v22, v13, v12, s35
  v_perm_b32 v19, v15, v14, s34
  v_perm_b32 v23, v15, v14, s35
  buffer_store_dwordx4 v[16:19], v6, s[16:19], 0 offen sc1
  buffer_store_dwordx4 v[20:23], v6, s[16:19], 0 offen offset:16 sc1
w1_end:
  s_mov_b64 exec, s[28:29]
  s_barrier
  s_barrier
  s_cmp_lg_u32 s2, 0
  s_cbranch_scc1 h_nocol0
  s_barrier
h_nocol0:
  s_barrier
  s_waitcnt vmcnt(0)
  s_barrier
  s_cmp_ge_u32 s2, 224
  s_cbranch_scc1 w2_end
  s_load_dwordx2 s[8:9], s[0:1], 40
  s_waitcnt lgkmcnt(0)
  s_mov_b32 s12, s8
  s_mov_b32 s13, s9
  s_mov_b32 s14, 0x1c0000
  s_mov_b32 s15, 0x00020000
  s_add_u32 s16, s4, 0x3d0000
  s_addc_u32 s17, s5, 0
  s_mov_b32 s18, 0x1c0000
  s_mov_b32 s19, 0x00020000
  s_and_b32 s25, s2, 7
  s_lshr_b32 s26, s2, 3
  v_and_b32 v1, 7, v0
  v_bfe_u32 v2, v0, 3, 2
  v_bfe_u32 v3, v0, 5, 2
  v_lshrrev_b32 v7, 7, v0
  s_lshl_b32 s27, s26, 1
  v_add_u32 v7, s27, v7
  v_lshlrev_b32 v4, 5, v7
  v_lshl_add_u32 v4, v2, 3, v4
  v_lshlrev_b32 v4, 10, v4
  s_lshl_b32 s31, s25, 7
  v_lshl_add_u32 v5, v3, 5, s31
  v_lshl_add_u32 v5, v1, 2, v5
  v_add_u32 v4, v4, v5
  s_movk_i32 s36, 4096
  buffer_load_dword v8, v4, s[12:15], 0 offen offset:0
  buffer_load_dword v9, v4, s[12:15], 0 offen offset:1024
  buffer_load_dword v10, v4, s[12:15], 0 offen offset:2048
  buffer_load_dword v11, v4, s[12:15], 0 offen offset:3072
  buffer_load_dword v12, v4, s[12:15], s36 offen offset:0
  buffer_load_dword v13, v4, s[12:15], s36 offen offset:1024
  buffer_load_dword v14, v4, s[12:15], s36 offen offset:2048
  buffer_load_dword v15, v4, s[12:15], s36 offen offset:3072
  s_mul_i32 s33, s25, 56
  v_add_u32 v6, s33, v7
  v_lshlrev_b32 v6, 12, v6
  v_lshl_add_u32 v6, v3, 10, v6
  v_lshl_add_u32 v6, v2, 8, v6
  v_lshl_add_u32 v6, v1, 5, v6
  s_mov_b32 s34, 0x05040100
  s_mov_b32 s35, 0x07060302
  s_waitcnt vmcnt(0)
  v_perm_b32 v16, v9, v8, s34
  v_perm_b32 v20, v9, v8, s35
  v_perm_b32 v17, v11, v10, s34
  v_perm_b32 v21, v11, v10, s35
  v_perm_b32 v18, v13, v12, s34
  v_perm_b32 v22, v13, v12, s35
  v_perm_b32 v19, v15, v14, s34
  v_perm_b32 v23, v15, v14, s35
  buffer_store_dwordx4 v[16:19], v6, s[16:19], 0 offen sc1
  buffer_store_dwordx4 v[20:23], v6, s[16:19], 0 offen offset:16 sc1
w2_end:
  s_barrier
  v_add_u32 v0, 256, v0
  v_mov_b32 v252, 151552
  ds_read_b64 v[254:255], v252
  s_waitcnt lgkmcnt(0)
  v_readfirstlane_b32 s71, v254
  v_readfirstlane_b32 s69, v255
  s_nop 3
  s_barrier
  s_bfe_u32 s20, s71, 0x40001
  v_and_b32 v2, 63, v0
  s_add_u32 s12, s4, 0x210000
  s_addc_u32 s13, s5, 0
  s_mov_b32 s14, 0x1c0000
  s_mov_b32 s15, 0x00020000
  v_lshlrev_b32 v7, 4, v2
  s_mul_i32 s25, s20, 114688
  s_sub_u32 s26, s95, 4
  s_lshl_b32 s26, s26, 10
  s_add_u32 s25, s25, s26
  s_add_u32 s27, s26, 36864
  s_mov_b32 m0, s27
  s_add_u32 s27, s27, 4096
  buffer_load_dwordx4 v7, s[12:15], s25 offen lds
  s_add_u32 s25, s25, 4096
  s_mov_b32 m0, s27
  s_add_u32 s27, s27, 4096
  buffer_load_dwordx4 v7, s[12:15], s25 offen lds
  s_add_u32 s25, s25, 4096
  s_mov_b32 m0, s27
  s_add_u32 s27, s27, 4096
  buffer_load_dwordx4 v7, s[12:15], s25 offen lds
  s_add_u32 s25, s25, 4096
  s_mov_b32 m0, s27
  s_add_u32 s27, s27, 4096
  buffer_load_dwordx4 v7, s[12:15], s25 offen lds
  s_add_u32 s25, s25, 4096
  s_mov_b32 m0, s27
  s_add_u32 s27, s27, 4096
  buffer_load_dwordx4 v7, s[12:15], s25 offen lds
  s_add_u32 s25, s25, 4096
  s_mov_b32 m0, s27
  s_add_u32 s27, s27, 4096
  buffer_load_dwordx4 v7, s[12:15], s25 offen lds
  s_add_u32 s25, s25, 4096
  s_mov_b32 m0, s27
  s_add_u32 s27, s27, 4096
  buffer_load_dwordx4 v7, s[12:15], s25 offen lds
  s_add_u32 s25, s25, 4096
  s_mov_b32 m0, s27
  s_add_u32 s27, s27, 4096
  buffer_load_dwordx4 v7, s[12:15], s25 offen lds
  s_add_u32 s25, s25, 4096
  s_mov_b32 m0, s27
  s_add_u32 s27, s27, 4096
  buffer_load_dwordx4 v7, s[12:15], s25 offen lds
  s_add_u32 s25, s25, 4096
  s_mov_b32 m0, s27
  s_add_u32 s27, s27, 4096
  buffer_load_dwordx4 v7, s[12:15], s25 offen lds
  s_add_u32 s25, s25, 4096
  s_mov_b32 m0, s27
  s_add_u32 s27, s27, 4096
  buffer_load_dwordx4 v7, s[12:15], s25 offen lds
  s_add_u32 s25, s25, 4096
  s_mov_b32 m0, s27
  s_add_u32 s27, s27, 4096
  buffer_load_dwordx4 v7, s[12:15], s25 offen lds
  s_add_u32 s25, s25, 4096
  s_mov_b32 m0, s27
  s_add_u32 s27, s27, 4096
  buffer_load_dwordx4 v7, s[12:15], s25 offen lds
  s_add_u32 s25, s25, 4096
  s_mov_b32 m0, s27
  s_add_u32 s27, s27, 4096
  buffer_load_dwordx4 v7, s[12:15], s25 offen lds
  s_add_u32 s25, s25, 4096
  s_mov_b32 m0, s27
  s_add_u32 s27, s27, 4096
  buffer_load_dwordx4 v7, s[12:15], s25 offen lds
  s_add_u32 s25, s25, 4096
  s_mov_b32 m0, s27
  s_add_u32 s27, s27, 4096
  buffer_load_dwordx4 v7, s[12:15], s25 offen lds
  s_add_u32 s25, s25, 4096
  s_mov_b32 m0, s27
  s_add_u32 s27, s27, 4096
  buffer_load_dwordx4 v7, s[12:15], s25 offen lds
  s_add_u32 s25, s25, 4096
  s_mov_b32 m0, s27
  s_add_u32 s27, s27, 4096
  buffer_load_dwordx4 v7, s[12:15], s25 offen lds
  s_add_u32 s25, s25, 4096
  s_mov_b32 m0, s27
  s_add_u32 s27, s27, 4096
  buffer_load_dwordx4 v7, s[12:15], s25 offen lds
  s_add_u32 s25, s25, 4096
  s_mov_b32 m0, s27
  s_add_u32 s27, s27, 4096
  buffer_load_dwordx4 v7, s[12:15], s25 offen lds
  s_add_u32 s25, s25, 4096
  s_mov_b32 m0, s27
  s_add_u32 s27, s27, 4096
  buffer_load_dwordx4 v7, s[12:15], s25 offen lds
  s_add_u32 s25, s25, 4096
  s_mov_b32 m0, s27
  s_add_u32 s27, s27, 4096
  buffer_load_dwordx4 v7, s[12:15], s25 offen lds
  s_add_u32 s25, s25, 4096
  s_mov_b32 m0, s27
  s_add_u32 s27, s27, 4096
  buffer_load_dwordx4 v7, s[12:15], s25 offen lds
  s_add_u32 s25, s25, 4096
  s_mov_b32 m0, s27
  s_add_u32 s27, s27, 4096
  buffer_load_dwordx4 v7, s[12:15], s25 offen lds
  s_add_u32 s25, s25, 4096
  s_mov_b32 m0, s27
  s_add_u32 s27, s27, 4096
  buffer_load_dwordx4 v7, s[12:15], s25 offen lds
  s_add_u32 s25, s25, 4096
  s_mov_b32 m0, s27
  s_add_u32 s27, s27, 4096
  buffer_load_dwordx4 v7, s[12:15], s25 offen lds
  s_add_u32 s25, s25, 4096
  s_mov_b32 m0, s27
  s_add_u32 s27, s27, 4096
  buffer_load_dwordx4 v7, s[12:15], s25 offen lds
  s_add_u32 s25, s25, 4096
  s_mov_b32 m0, s27
  s_add_u32 s27, s27, 4096
  buffer_load_dwordx4 v7, s[12:15], s25 offen lds
  s_add_u32 s25, s25, 4096
  s_barrier
  s_waitcnt vmcnt(0)
  s_barrier
join:
  s_lshr_b32 s21, s71, 5
  s_lshl_b32 s21, s21, 1
  s_and_b32 s20, s71, 1
  s_add_u32 s21, s21, s20
  s_bfe_u32 s20, s71, 0x40001
  s_and_b32 s22, s95, 3
  s_lshr_b32 s34, s95, 2
  v_and_b32 v2, 63, v0
  v_and_b32 v3, 15, v0
  v_bfe_u32 v4, v0, 4, 2
  s_add_u32 s8, s4, 0xf90000
  s_addc_u32 s9, s5, 0
  s_mov_b32 s10, 0x200000
  s_mov_b32 s11, 0x00020000
  s_add_u32 s16, s4, 0x1190000
  s_addc_u32 s17, s5, 0
  s_mov_b32 s18, 0x700000
  s_mov_b32 s19, 0x00020000
  s_lshl_b32 s23, s21, 3
  s_lshl_b32 s24, s22, 1
  s_add_u32 s23, s23, s24
  s_lshl_b32 s23, s23, 14
  v_lshl_add_u32 v5, v2, 4, s23
  v_add_u32 v6, 16384, v5
  v_lshlrev_b32 v7, 4, v2
  s_lshl_b32 s35, s34, 12
  s_add_u32 s35, s35, 36864
  v_add_u32 v7, s35, v7
  v_add_u32 v8, 57344, v7
  v_mov_b32 v192, 0
  v_mov_b32 v193, 0
  v_mov_b32 v194, 0
  v_mov_b32 v195, 0
  v_mov_b32 v196, 0
  v_mov_b32 v197, 0
  v_mov_b32 v198, 0
  v_mov_b32 v199, 0
  v_mov_b32 v200, 0
  v_mov_b32 v201, 0
  v_mov_b32 v202, 0
  v_mov_b32 v203, 0
  v_mov_b32 v204, 0
  v_mov_b32 v205, 0
  v_mov_b32 v206, 0
  v_mov_b32 v207, 0
  v_mov_b32 v208, 0
  v_mov_b32 v209, 0
  v_mov_b32 v210, 0
  v_mov_b32 v211, 0
  v_mov_b32 v212, 0
  v_mov_b32 v213, 0
  v_mov_b32 v214, 0
  v_mov_b32 v215, 0
  v_mov_b32 v216, 0
  v_mov_b32 v217, 0
  v_mov_b32 v218, 0
  v_mov_b32 v219, 0
  v_mov_b32 v220, 0
  v_mov_b32 v221, 0
  v_mov_b32 v222, 0
  v_mov_b32 v223, 0
  v_lshrrev_b32 v9, 1, v4
  v_lshlrev_b32 v9, 8, v9
  v_lshl_add_u32 v9, v3, 4, v9
  v_and_b32 v10, 1, v4
  v_mul_u32_u24 v10, 57344, v10
  v_add_u32 v9, v9, v10
  s_lshl_b32 s28, s21, 3
  s_lshl_b32 s29, s22, 1
  s_add_u32 s28, s28, s29
  s_mul_i32 s28, s28, 57344
  s_mul_i32 s30, s20, 7
  s_lshl_b32 s29, s34, 2
  s_add_u32 s30, s30, s29
  s_mov_b32 s40, 0xbfb8aa3b
  s_mov_b32 s41, 0xbfb8aa3b
  s_movk_i32 s45, 4096
  s_movk_i32 s46, 8192
  s_movk_i32 s47, 12288
  s_mov_b32 s42, 1.0
  s_mov_b32 s43, 1.0
  s_waitcnt vmcnt(0)
  s_cmp_lg_u32 s95, 0
  s_cbranch_scc1 wait_skip_d
  v_and_b32 v253, 63, v0
  v_lshlrev_b32 v253, 6, v253
  s_cmp_eq_u32 s69, 1
  s_cbranch_scc0 wait_loop_d
  s_lshr_b32 s94, s71, 5
  s_lshl_b32 s94, s94, 11
  s_mov_b64 s[92:93], exec
  s_mov_b64 exec, 0xffffffff
wait_floop_d:
  buffer_load_dword v254, v253, s[64:67], s94 offen sc1
  s_waitcnt vmcnt(0)
  v_cmp_gt_u32 vcc, 4, v254
  s_cmp_eq_u64 vcc, 0
  s_cbranch_scc0 wait_floop_d
  s_mov_b64 exec, s[92:93]
  s_branch wait_skip_d
wait_loop_d:
  s_movk_i32 s94, 0
  buffer_load_dword v249, v253, s[64:67], s94 offen sc1
  s_movk_i32 s94, 4096
  buffer_load_dword v250, v253, s[64:67], s94 offen sc1
  s_movk_i32 s94, 8192
  buffer_load_dword v251, v253, s[64:67], s94 offen sc1
  s_movk_i32 s94, 12288
  buffer_load_dword v252, v253, s[64:67], s94 offen sc1
  s_waitcnt vmcnt(0)
  v_min_u32 v249, v249, v250
  v_min_u32 v251, v251, v252
  v_min_u32 v249, v249, v251
  v_cmp_gt_u32 vcc, 4, v249
  s_cmp_eq_u64 vcc, 0
  s_cbranch_scc1 wait_skip_d
  s_sleep 3
  s_branch wait_loop_d
wait_skip_d:
  s_barrier
  buffer_load_dwordx4 v[64:67], v5, s[8:11], 0 offen offset:0
  buffer_load_dwordx4 v[128:131], v6, s[8:11], 0 offen offset:0
  buffer_load_dwordx4 v[68:71], v5, s[8:11], 0 offen offset:1024
  buffer_load_dwordx4 v[132:135], v6, s[8:11], 0 offen offset:1024
  buffer_load_dwordx4 v[72:75], v5, s[8:11], 0 offen offset:2048
  buffer_load_dwordx4 v[136:139], v6, s[8:11], 0 offen offset:2048
  buffer_load_dwordx4 v[76:79], v5, s[8:11], 0 offen offset:3072
  buffer_load_dwordx4 v[140:143], v6, s[8:11], 0 offen offset:3072
  buffer_load_dwordx4 v[80:83], v5, s[8:11], s45 offen offset:0
  buffer_load_dwordx4 v[144:147], v6, s[8:11], s45 offen offset:0
  buffer_load_dwordx4 v[84:87], v5, s[8:11], s45 offen offset:1024
  buffer_load_dwordx4 v[148:151], v6, s[8:11], s45 offen offset:1024
  buffer_load_dwordx4 v[88:91], v5, s[8:11], s45 offen offset:2048
  buffer_load_dwordx4 v[152:155], v6, s[8:11], s45 offen offset:2048
  buffer_load_dwordx4 v[92:95], v5, s[8:11], s45 offen offset:3072
  buffer_load_dwordx4 v[156:159], v6, s[8:11], s45 offen offset:3072
  buffer_load_dwordx4 v[96:99], v5, s[8:11], s46 offen offset:0
  buffer_load_dwordx4 v[160:163], v6, s[8:11], s46 offen offset:0
  buffer_load_dwordx4 v[100:103], v5, s[8:11], s46 offen offset:1024
  buffer_load_dwordx4 v[164:167], v6, s[8:11], s46 offen offset:1024
  buffer_load_dwordx4 v[104:107], v5, s[8:11], s46 offen offset:2048
  buffer_load_dwordx4 v[168:171], v6, s[8:11], s46 offen offset:2048
  buffer_load_dwordx4 v[108:111], v5, s[8:11], s46 offen offset:3072
  buffer_load_dwordx4 v[172:175], v6, s[8:11], s46 offen offset:3072
  buffer_load_dwordx4 v[112:115], v5, s[8:11], s47 offen offset:0
  buffer_load_dwordx4 v[176:179], v6, s[8:11], s47 offen offset:0
  buffer_load_dwordx4 v[116:119], v5, s[8:11], s47 offen offset:1024
  buffer_load_dwordx4 v[180:183], v6, s[8:11], s47 offen offset:1024
  buffer_load_dwordx4 v[120:123], v5, s[8:11], s47 offen offset:2048
  buffer_load_dwordx4 v[184:187], v6, s[8:11], s47 offen offset:2048
  buffer_load_dwordx4 v[124:127], v5, s[8:11], s47 offen offset:3072
  buffer_load_dwordx4 v[188:191], v6, s[8:11], s47 offen offset:3072
  s_cmp_lg_u32 s34, 0
  s_cbranch_scc1 g1_cg1
  ds_read_b128 v[40:43], v7 offset:0
  ds_read_b128 v[44:47], v7 offset:7168
  ds_read_b128 v[48:51], v7 offset:14336
  ds_read_b128 v[52:55], v7 offset:21504
  ds_read_b128 v[56:59], v7 offset:28672
  ds_read_b128 v[60:63], v7 offset:35840
  s_waitcnt vmcnt(30) lgkmcnt(5)
  v_mfma_f32_16x16x32_bf16 v[192:195], v[40:43], v[64:67], v[192:195]
  v_mfma_f32_16x16x32_bf16 v[208:211], v[40:43], v[128:131], v[208:211]
  ds_read_b128 v[40:43], v7 offset:43008
  s_waitcnt vmcnt(28) lgkmcnt(5)
  v_mfma_f32_16x16x32_bf16 v[192:195], v[44:47], v[68:71], v[192:195]
  v_mfma_f32_16x16x32_bf16 v[208:211], v[44:47], v[132:135], v[208:211]
  ds_read_b128 v[44:47], v7 offset:50176
  s_waitcnt vmcnt(26) lgkmcnt(5)
  v_mfma_f32_16x16x32_bf16 v[192:195], v[48:51], v[72:75], v[192:195]
  v_mfma_f32_16x16x32_bf16 v[208:211], v[48:51], v[136:139], v[208:211]
  ds_read_b128 v[48:51], v8 offset:0
  s_waitcnt vmcnt(24) lgkmcnt(5)
  v_mfma_f32_16x16x32_bf16 v[192:195], v[52:55], v[76:79], v[192:195]
  v_mfma_f32_16x16x32_bf16 v[208:211], v[52:55], v[140:143], v[208:211]
  ds_read_b128 v[52:55], v8 offset:7168
  s_waitcnt vmcnt(22) lgkmcnt(5)
  v_mfma_f32_16x16x32_bf16 v[192:195], v[56:59], v[80:83], v[192:195]
  v_mfma_f32_16x16x32_bf16 v[208:211], v[56:59], v[144:147], v[208:211]
  ds_read_b128 v[56:59], v8 offset:14336
  s_waitcnt vmcnt(20) lgkmcnt(5)
  v_mfma_f32_16x16x32_bf16 v[192:195], v[60:63], v[84:87], v[192:195]
  v_mfma_f32_16x16x32_bf16 v[208:211], v[60:63], v[148:151], v[208:211]
  ds_read_b128 v[60:63], v8 offset:21504
  s_waitcnt vmcnt(18) lgkmcnt(5)
  v_mfma_f32_16x16x32_bf16 v[192:195], v[40:43], v[88:91], v[192:195]
  v_mfma_f32_16x16x32_bf16 v[208:211], v[40:43], v[152:155], v[208:211]
  ds_read_b128 v[40:43], v8 offset:28672
  s_waitcnt vmcnt(16) lgkmcnt(5)
  v_mfma_f32_16x16x32_bf16 v[192:195], v[44:47], v[92:95], v[192:195]
  v_mfma_f32_16x16x32_bf16 v[208:211], v[44:47], v[156:159], v[208:211]
  ds_read_b128 v[44:47], v8 offset:35840
  s_waitcnt vmcnt(14) lgkmcnt(5)
  v_mfma_f32_16x16x32_bf16 v[192:195], v[48:51], v[96:99], v[192:195]
  v_mfma_f32_16x16x32_bf16 v[208:211], v[48:51], v[160:163], v[208:211]
  ds_read_b128 v[48:51], v8 offset:43008
  s_waitcnt vmcnt(12) lgkmcnt(5)
  v_mfma_f32_16x16x32_bf16 v[192:195], v[52:55], v[100:103], v[192:195]
  v_mfma_f32_16x16x32_bf16 v[208:211], v[52:55], v[164:167], v[208:211]
  ds_read_b128 v[52:55], v8 offset:50176
  s_waitcnt vmcnt(10) lgkmcnt(5)
  v_mfma_f32_16x16x32_bf16 v[192:195], v[56:59], v[104:107], v[192:195]
  v_mfma_f32_16x16x32_bf16 v[208:211], v[56:59], v[168:171], v[208:211]
  ds_read_b128 v[56:59], v7 offset:1024
  s_waitcnt vmcnt(8) lgkmcnt(5)
  v_mfma_f32_16x16x32_bf16 v[192:195], v[60:63], v[108:111], v[192:195]
  v_mfma_f32_16x16x32_bf16 v[208:211], v[60:63], v[172:175], v[208:211]
  ds_read_b128 v[60:63], v7 offset:8192
  s_waitcnt vmcnt(6) lgkmcnt(5)
  v_mfma_f32_16x16x32_bf16 v[192:195], v[40:43], v[112:115], v[192:195]
  v_mfma_f32_16x16x32_bf16 v[208:211], v[40:43], v[176:179], v[208:211]
  ds_read_b128 v[40:43], v7 offset:15360
  s_waitcnt vmcnt(4) lgkmcnt(5)
  v_mfma_f32_16x16x32_bf16 v[192:195], v[44:47], v[116:119], v[192:195]
  v_mfma_f32_16x16x32_bf16 v[208:211], v[44:47], v[180:183], v[208:211]
  ds_read_b128 v[44:47], v7 offset:22528
  s_waitcnt vmcnt(2) lgkmcnt(5)
  v_mfma_f32_16x16x32_bf16 v[192:195], v[48:51], v[120:123], v[192:195]
  v_mfma_f32_16x16x32_bf16 v[208:211], v[48:51], v[184:187], v[208:211]
  ds_read_b128 v[48:51], v7 offset:29696
  s_waitcnt vmcnt(0) lgkmcnt(5)
  v_mfma_f32_16x16x32_bf16 v[192:195], v[52:55], v[124:127], v[192:195]
  v_mfma_f32_16x16x32_bf16 v[208:211], v[52:55], v[188:191], v[208:211]
  ds_read_b128 v[52:55], v7 offset:36864
  s_waitcnt lgkmcnt(5)
  v_mfma_f32_16x16x32_bf16 v[196:199], v[56:59], v[64:67], v[196:199]
  v_mfma_f32_16x16x32_bf16 v[212:215], v[56:59], v[128:131], v[212:215]
  ds_read_b128 v[56:59], v7 offset:44032
  s_waitcnt lgkmcnt(5)
  v_mfma_f32_16x16x32_bf16 v[196:199], v[60:63], v[68:71], v[196:199]
  v_mfma_f32_16x16x32_bf16 v[212:215], v[60:63], v[132:135], v[212:215]
  ds_read_b128 v[60:63], v7 offset:51200
  s_waitcnt lgkmcnt(5)
  v_mfma_f32_16x16x32_bf16 v[196:199], v[40:43], v[72:75], v[196:199]
  v_mfma_f32_16x16x32_bf16 v[212:215], v[40:43], v[136:139], v[212:215]
  ds_read_b128 v[40:43], v8 offset:1024
  s_waitcnt lgkmcnt(5)
  v_mfma_f32_16x16x32_bf16 v[196:199], v[44:47], v[76:79], v[196:199]
  v_mfma_f32_16x16x32_bf16 v[212:215], v[44:47], v[140:143], v[212:215]
  ds_read_b128 v[44:47], v8 offset:8192
  s_waitcnt lgkmcnt(5)
  v_mfma_f32_16x16x32_bf16 v[196:199], v[48:51], v[80:83], v[196:199]
  v_mfma_f32_16x16x32_bf16 v[212:215], v[48:51], v[144:147], v[212:215]
  v_cvt_pk_bf16_f32 v20, v192, v193
  v_lshlrev_b32 v16, 16, v20
  v_and_b32 v17, 0xffff0000, v20
  v_cvt_pk_bf16_f32 v20, v194, v195
  v_lshlrev_b32 v18, 16, v20
  ds_read_b128 v[48:51], v8 offset:15360
  s_waitcnt lgkmcnt(5)
  v_mfma_f32_16x16x32_bf16 v[196:199], v[52:55], v[84:87], v[196:199]
  v_mfma_f32_16x16x32_bf16 v[212:215], v[52:55], v[148:151], v[212:215]
  v_and_b32 v19, 0xffff0000, v20
  v_pk_mul_f32 v[20:21], v[16:17], s[40:41]
  v_pk_mul_f32 v[22:23], v[18:19], s[40:41]
  v_exp_f32 v20, v20
  v_exp_f32 v21, v21
  ds_read_b128 v[52:55], v8 offset:22528
  s_waitcnt lgkmcnt(5)
  v_mfma_f32_16x16x32_bf16 v[196:199], v[56:59], v[88:91], v[196:199]
  v_mfma_f32_16x16x32_bf16 v[212:215], v[56:59], v[152:155], v[212:215]
  v_exp_f32 v22, v22
  v_exp_f32 v23, v23
  v_pk_add_f32 v[20:21], v[20:21], s[42:43]
  v_pk_add_f32 v[22:23], v[22:23], s[42:43]
  v_rcp_f32 v20, v20
  ds_read_b128 v[56:59], v8 offset:29696
  s_waitcnt lgkmcnt(5)
  v_mfma_f32_16x16x32_bf16 v[196:199], v[60:63], v[92:95], v[196:199]
  v_mfma_f32_16x16x32_bf16 v[212:215], v[60:63], v[156:159], v[212:215]
  v_rcp_f32 v21, v21
  v_rcp_f32 v22, v22
  v_rcp_f32 v23, v23
  v_pk_mul_f32 v[16:17], v[16:17], v[20:21]
  v_pk_mul_f32 v[18:19], v[18:19], v[22:23]
  ds_read_b128 v[60:63], v8 offset:36864
  s_waitcnt lgkmcnt(5)
  v_mfma_f32_16x16x32_bf16 v[196:199], v[40:43], v[96:99], v[196:199]
  v_mfma_f32_16x16x32_bf16 v[212:215], v[40:43], v[160:163], v[212:215]
  v_cvt_pk_bf16_f32 v12, v16, v17
  v_cvt_pk_bf16_f32 v13, v18, v19
  v_cvt_pk_bf16_f32 v28, v208, v209
  v_lshlrev_b32 v24, 16, v28
  v_and_b32 v25, 0xffff0000, v28
  ds_read_b128 v[40:43], v8 offset:44032
  s_waitcnt lgkmcnt(5)
  v_mfma_f32_16x16x32_bf16 v[196:199], v[44:47], v[100:103], v[196:199]
  v_mfma_f32_16x16x32_bf16 v[212:215], v[44:47], v[164:167], v[212:215]
  v_cvt_pk_bf16_f32 v28, v210, v211
  v_lshlrev_b32 v26, 16, v28
  v_and_b32 v27, 0xffff0000, v28
  v_pk_mul_f32 v[28:29], v[24:25], s[40:41]
  v_pk_mul_f32 v[30:31], v[26:27], s[40:41]
  ds_read_b128 v[44:47], v8 offset:51200
  s_waitcnt lgkmcnt(5)
  v_mfma_f32_16x16x32_bf16 v[196:199], v[48:51], v[104:107], v[196:199]
  v_mfma_f32_16x16x32_bf16 v[212:215], v[48:51], v[168:171], v[212:215]
  v_exp_f32 v28, v28
  v_exp_f32 v29, v29
  v_exp_f32 v30, v30
  v_exp_f32 v31, v31
  v_pk_add_f32 v[28:29], v[28:29], s[42:43]
  ds_read_b128 v[48:51], v7 offset:2048
  s_waitcnt lgkmcnt(5)
  v_mfma_f32_16x16x32_bf16 v[196:199], v[52:55], v[108:111], v[196:199]
  v_mfma_f32_16x16x32_bf16 v[212:215], v[52:55], v[172:175], v[212:215]
  v_pk_add_f32 v[30:31], v[30:31], s[42:43]
  v_rcp_f32 v28, v28
  v_rcp_f32 v29, v29
  v_rcp_f32 v30, v30
  v_rcp_f32 v31, v31
  ds_read_b128 v[52:55], v7 offset:9216
  s_waitcnt lgkmcnt(5)
  v_mfma_f32_16x16x32_bf16 v[196:199], v[56:59], v[112:115], v[196:199]
  v_mfma_f32_16x16x32_bf16 v[212:215], v[56:59], v[176:179], v[212:215]
  v_pk_mul_f32 v[24:25], v[24:25], v[28:29]
  v_pk_mul_f32 v[26:27], v[26:27], v[30:31]
  v_cvt_pk_bf16_f32 v14, v24, v25
  v_cvt_pk_bf16_f32 v15, v26, v27
  s_add_u32 s31, s30, 0
  ds_read_b128 v[56:59], v7 offset:16384
  s_waitcnt lgkmcnt(5)
  v_mfma_f32_16x16x32_bf16 v[196:199], v[60:63], v[116:119], v[196:199]
  v_mfma_f32_16x16x32_bf16 v[212:215], v[60:63], v[180:183], v[212:215]
  s_lshr_b32 s32, s31, 1
  s_lshl_b32 s32, s32, 10
  s_and_b32 s33, s31, 1
  s_lshl_b32 s33, s33, 9
  s_add_u32 s32, s32, s33
  ds_read_b128 v[60:63], v7 offset:23552
  s_waitcnt lgkmcnt(5)
  v_mfma_f32_16x16x32_bf16 v[196:199], v[40:43], v[120:123], v[196:199]
  v_mfma_f32_16x16x32_bf16 v[212:215], v[40:43], v[184:187], v[212:215]
  s_add_u32 s32, s32, s28
  v_permlane16_swap_b32 v12, v14
  v_permlane16_swap_b32 v13, v15
  s_nop 0
  s_cmp_eq_u32 s69, 1
  s_cbranch_scc1 sdf_5
  buffer_store_dwordx4 v[12:15], v9, s[16:19], s32 offen sc1
  s_branch sde_5
sdf_5:
  buffer_store_dwordx4 v[12:15], v9, s[16:19], s32 offen
sde_5:
  ds_read_b128 v[40:43], v7 offset:30720
  s_waitcnt lgkmcnt(5)
  v_mfma_f32_16x16x32_bf16 v[196:199], v[44:47], v[124:127], v[196:199]
  v_mfma_f32_16x16x32_bf16 v[212:215], v[44:47], v[188:191], v[212:215]
  s_nop 1
  ds_read_b128 v[44:47], v7 offset:37888
  s_waitcnt lgkmcnt(5)
  v_mfma_f32_16x16x32_bf16 v[200:203], v[48:51], v[64:67], v[200:203]
  v_mfma_f32_16x16x32_bf16 v[216:219], v[48:51], v[128:131], v[216:219]
  ds_read_b128 v[48:51], v7 offset:45056
  s_waitcnt lgkmcnt(5)
  v_mfma_f32_16x16x32_bf16 v[200:203], v[52:55], v[68:71], v[200:203]
  v_mfma_f32_16x16x32_bf16 v[216:219], v[52:55], v[132:135], v[216:219]
  ds_read_b128 v[52:55], v7 offset:52224
  s_waitcnt lgkmcnt(5)
  v_mfma_f32_16x16x32_bf16 v[200:203], v[56:59], v[72:75], v[200:203]
  v_mfma_f32_16x16x32_bf16 v[216:219], v[56:59], v[136:139], v[216:219]
  ds_read_b128 v[56:59], v8 offset:2048
  s_waitcnt lgkmcnt(5)
  v_mfma_f32_16x16x32_bf16 v[200:203], v[60:63], v[76:79], v[200:203]
  v_mfma_f32_16x16x32_bf16 v[216:219], v[60:63], v[140:143], v[216:219]
  ds_read_b128 v[60:63], v8 offset:9216
  s_waitcnt lgkmcnt(5)
  v_mfma_f32_16x16x32_bf16 v[200:203], v[40:43], v[80:83], v[200:203]
  v_mfma_f32_16x16x32_bf16 v[216:219], v[40:43], v[144:147], v[216:219]
  v_cvt_pk_bf16_f32 v20, v196, v197
  v_lshlrev_b32 v16, 16, v20
  v_and_b32 v17, 0xffff0000, v20
  v_cvt_pk_bf16_f32 v20, v198, v199
  v_lshlrev_b32 v18, 16, v20
  ds_read_b128 v[40:43], v8 offset:16384
  s_waitcnt lgkmcnt(5)
  v_mfma_f32_16x16x32_bf16 v[200:203], v[44:47], v[84:87], v[200:203]
  v_mfma_f32_16x16x32_bf16 v[216:219], v[44:47], v[148:151], v[216:219]
  v_and_b32 v19, 0xffff0000, v20
  v_pk_mul_f32 v[20:21], v[16:17], s[40:41]
  v_pk_mul_f32 v[22:23], v[18:19], s[40:41]
  v_exp_f32 v20, v20
  v_exp_f32 v21, v21
  ds_read_b128 v[44:47], v8 offset:23552
  s_waitcnt lgkmcnt(5)
  v_mfma_f32_16x16x32_bf16 v[200:203], v[48:51], v[88:91], v[200:203]
  v_mfma_f32_16x16x32_bf16 v[216:219], v[48:51], v[152:155], v[216:219]
  v_exp_f32 v22, v22
  v_exp_f32 v23, v23
  v_pk_add_f32 v[20:21], v[20:21], s[42:43]
  v_pk_add_f32 v[22:23], v[22:23], s[42:43]
  v_rcp_f32 v20, v20
  ds_read_b128 v[48:51], v8 offset:30720
  s_waitcnt lgkmcnt(5)
  v_mfma_f32_16x16x32_bf16 v[200:203], v[52:55], v[92:95], v[200:203]
  v_mfma_f32_16x16x32_bf16 v[216:219], v[52:55], v[156:159], v[216:219]
  v_rcp_f32 v21, v21
  v_rcp_f32 v22, v22
  v_rcp_f32 v23, v23
  v_pk_mul_f32 v[16:17], v[16:17], v[20:21]
  v_pk_mul_f32 v[18:19], v[18:19], v[22:23]
  ds_read_b128 v[52:55], v8 offset:37888
  s_waitcnt lgkmcnt(5)
  v_mfma_f32_16x16x32_bf16 v[200:203], v[56:59], v[96:99], v[200:203]
  v_mfma_f32_16x16x32_bf16 v[216:219], v[56:59], v[160:163], v[216:219]
  v_cvt_pk_bf16_f32 v12, v16, v17
  v_cvt_pk_bf16_f32 v13, v18, v19
  v_cvt_pk_bf16_f32 v28, v212, v213
  v_lshlrev_b32 v24, 16, v28
  v_and_b32 v25, 0xffff0000, v28
  ds_read_b128 v[56:59], v8 offset:45056
  s_waitcnt lgkmcnt(5)
  v_mfma_f32_16x16x32_bf16 v[200:203], v[60:63], v[100:103], v[200:203]
  v_mfma_f32_16x16x32_bf16 v[216:219], v[60:63], v[164:167], v[216:219]
  v_cvt_pk_bf16_f32 v28, v214, v215
  v_lshlrev_b32 v26, 16, v28
  v_and_b32 v27, 0xffff0000, v28
  v_pk_mul_f32 v[28:29], v[24:25], s[40:41]
  v_pk_mul_f32 v[30:31], v[26:27], s[40:41]
  ds_read_b128 v[60:63], v8 offset:52224
  s_waitcnt lgkmcnt(5)
  v_mfma_f32_16x16x32_bf16 v[200:203], v[40:43], v[104:107], v[200:203]
  v_mfma_f32_16x16x32_bf16 v[216:219], v[40:43], v[168:171], v[216:219]
  v_exp_f32 v28, v28
  v_exp_f32 v29, v29
  v_exp_f32 v30, v30
  v_exp_f32 v31, v31
  v_pk_add_f32 v[28:29], v[28:29], s[42:43]
  ds_read_b128 v[40:43], v7 offset:3072
  s_waitcnt lgkmcnt(5)
  v_mfma_f32_16x16x32_bf16 v[200:203], v[44:47], v[108:111], v[200:203]
  v_mfma_f32_16x16x32_bf16 v[216:219], v[44:47], v[172:175], v[216:219]
  v_pk_add_f32 v[30:31], v[30:31], s[42:43]
  v_rcp_f32 v28, v28
  v_rcp_f32 v29, v29
  v_rcp_f32 v30, v30
  v_rcp_f32 v31, v31
  ds_read_b128 v[44:47], v7 offset:10240
  s_waitcnt lgkmcnt(5)
  v_mfma_f32_16x16x32_bf16 v[200:203], v[48:51], v[112:115], v[200:203]
  v_mfma_f32_16x16x32_bf16 v[216:219], v[48:51], v[176:179], v[216:219]
  v_pk_mul_f32 v[24:25], v[24:25], v[28:29]
  v_pk_mul_f32 v[26:27], v[26:27], v[30:31]
  v_cvt_pk_bf16_f32 v14, v24, v25
  v_cvt_pk_bf16_f32 v15, v26, v27
  s_add_u32 s31, s30, 1
  ds_read_b128 v[48:51], v7 offset:17408
  s_waitcnt lgkmcnt(5)
  v_mfma_f32_16x16x32_bf16 v[200:203], v[52:55], v[116:119], v[200:203]
  v_mfma_f32_16x16x32_bf16 v[216:219], v[52:55], v[180:183], v[216:219]
  s_lshr_b32 s32, s31, 1
  s_lshl_b32 s32, s32, 10
  s_and_b32 s33, s31, 1
  s_lshl_b32 s33, s33, 9
  s_add_u32 s32, s32, s33
  ds_read_b128 v[52:55], v7 offset:24576
  s_waitcnt lgkmcnt(5)
  v_mfma_f32_16x16x32_bf16 v[200:203], v[56:59], v[120:123], v[200:203]
  v_mfma_f32_16x16x32_bf16 v[216:219], v[56:59], v[184:187], v[216:219]
  s_add_u32 s32, s32, s28
  v_permlane16_swap_b32 v12, v14
  v_permlane16_swap_b32 v13, v15
  s_nop 0
  s_cmp_eq_u32 s69, 1
  s_cbranch_scc1 sdf_6
  buffer_store_dwordx4 v[12:15], v9, s[16:19], s32 offen sc1
  s_branch sde_6
sdf_6:
  buffer_store_dwordx4 v[12:15], v9, s[16:19], s32 offen
sde_6:
  ds_read_b128 v[56:59], v7 offset:31744
  s_waitcnt lgkmcnt(5)
  v_mfma_f32_16x16x32_bf16 v[200:203], v[60:63], v[124:127], v[200:203]
  v_mfma_f32_16x16x32_bf16 v[216:219], v[60:63], v[188:191], v[216:219]
  s_nop 1
  ds_read_b128 v[60:63], v7 offset:38912
  s_waitcnt lgkmcnt(5)
  v_mfma_f32_16x16x32_bf16 v[204:207], v[40:43], v[64:67], v[204:207]
  v_mfma_f32_16x16x32_bf16 v[220:223], v[40:43], v[128:131], v[220:223]
  ds_read_b128 v[40:43], v7 offset:46080
  s_waitcnt lgkmcnt(5)
  v_mfma_f32_16x16x32_bf16 v[204:207], v[44:47], v[68:71], v[204:207]
  v_mfma_f32_16x16x32_bf16 v[220:223], v[44:47], v[132:135], v[220:223]
  ds_read_b128 v[44:47], v7 offset:53248
  s_waitcnt lgkmcnt(5)
  v_mfma_f32_16x16x32_bf16 v[204:207], v[48:51], v[72:75], v[204:207]
  v_mfma_f32_16x16x32_bf16 v[220:223], v[48:51], v[136:139], v[220:223]
  ds_read_b128 v[48:51], v8 offset:3072
  s_waitcnt lgkmcnt(5)
  v_mfma_f32_16x16x32_bf16 v[204:207], v[52:55], v[76:79], v[204:207]
  v_mfma_f32_16x16x32_bf16 v[220:223], v[52:55], v[140:143], v[220:223]
  ds_read_b128 v[52:55], v8 offset:10240
  s_waitcnt lgkmcnt(5)
  v_mfma_f32_16x16x32_bf16 v[204:207], v[56:59], v[80:83], v[204:207]
  v_mfma_f32_16x16x32_bf16 v[220:223], v[56:59], v[144:147], v[220:223]
  v_cvt_pk_bf16_f32 v20, v200, v201
  v_lshlrev_b32 v16, 16, v20
  v_and_b32 v17, 0xffff0000, v20
  v_cvt_pk_bf16_f32 v20, v202, v203
  v_lshlrev_b32 v18, 16, v20
  ds_read_b128 v[56:59], v8 offset:17408
  s_waitcnt lgkmcnt(5)
  v_mfma_f32_16x16x32_bf16 v[204:207], v[60:63], v[84:87], v[204:207]
  v_mfma_f32_16x16x32_bf16 v[220:223], v[60:63], v[148:151], v[220:223]
  v_and_b32 v19, 0xffff0000, v20
  v_pk_mul_f32 v[20:21], v[16:17], s[40:41]
  v_pk_mul_f32 v[22:23], v[18:19], s[40:41]
  v_exp_f32 v20, v20
  v_exp_f32 v21, v21
  ds_read_b128 v[60:63], v8 offset:24576
  s_waitcnt lgkmcnt(5)
  v_mfma_f32_16x16x32_bf16 v[204:207], v[40:43], v[88:91], v[204:207]
  v_mfma_f32_16x16x32_bf16 v[220:223], v[40:43], v[152:155], v[220:223]
  v_exp_f32 v22, v22
  v_exp_f32 v23, v23
  v_pk_add_f32 v[20:21], v[20:21], s[42:43]
  v_pk_add_f32 v[22:23], v[22:23], s[42:43]
  v_rcp_f32 v20, v20
  ds_read_b128 v[40:43], v8 offset:31744
  s_waitcnt lgkmcnt(5)
  v_mfma_f32_16x16x32_bf16 v[204:207], v[44:47], v[92:95], v[204:207]
  v_mfma_f32_16x16x32_bf16 v[220:223], v[44:47], v[156:159], v[220:223]
  v_rcp_f32 v21, v21
  v_rcp_f32 v22, v22
  v_rcp_f32 v23, v23
  v_pk_mul_f32 v[16:17], v[16:17], v[20:21]
  v_pk_mul_f32 v[18:19], v[18:19], v[22:23]
  ds_read_b128 v[44:47], v8 offset:38912
  s_waitcnt lgkmcnt(5)
  v_mfma_f32_16x16x32_bf16 v[204:207], v[48:51], v[96:99], v[204:207]
  v_mfma_f32_16x16x32_bf16 v[220:223], v[48:51], v[160:163], v[220:223]
  v_cvt_pk_bf16_f32 v12, v16, v17
  v_cvt_pk_bf16_f32 v13, v18, v19
  v_cvt_pk_bf16_f32 v28, v216, v217
  v_lshlrev_b32 v24, 16, v28
  v_and_b32 v25, 0xffff0000, v28
  ds_read_b128 v[48:51], v8 offset:46080
  s_waitcnt lgkmcnt(5)
  v_mfma_f32_16x16x32_bf16 v[204:207], v[52:55], v[100:103], v[204:207]
  v_mfma_f32_16x16x32_bf16 v[220:223], v[52:55], v[164:167], v[220:223]
  v_cvt_pk_bf16_f32 v28, v218, v219
  v_lshlrev_b32 v26, 16, v28
  v_and_b32 v27, 0xffff0000, v28
  v_pk_mul_f32 v[28:29], v[24:25], s[40:41]
  v_pk_mul_f32 v[30:31], v[26:27], s[40:41]
  ds_read_b128 v[52:55], v8 offset:53248
  s_waitcnt lgkmcnt(5)
  v_mfma_f32_16x16x32_bf16 v[204:207], v[56:59], v[104:107], v[204:207]
  v_mfma_f32_16x16x32_bf16 v[220:223], v[56:59], v[168:171], v[220:223]
  v_exp_f32 v28, v28
  v_exp_f32 v29, v29
  v_exp_f32 v30, v30
  v_exp_f32 v31, v31
  v_pk_add_f32 v[28:29], v[28:29], s[42:43]
  s_waitcnt lgkmcnt(4)
  v_mfma_f32_16x16x32_bf16 v[204:207], v[60:63], v[108:111], v[204:207]
  v_mfma_f32_16x16x32_bf16 v[220:223], v[60:63], v[172:175], v[220:223]
  v_pk_add_f32 v[30:31], v[30:31], s[42:43]
  v_rcp_f32 v28, v28
  v_rcp_f32 v29, v29
  v_rcp_f32 v30, v30
  v_rcp_f32 v31, v31
  s_waitcnt lgkmcnt(3)
  v_mfma_f32_16x16x32_bf16 v[204:207], v[40:43], v[112:115], v[204:207]
  v_mfma_f32_16x16x32_bf16 v[220:223], v[40:43], v[176:179], v[220:223]
  v_pk_mul_f32 v[24:25], v[24:25], v[28:29]
  v_pk_mul_f32 v[26:27], v[26:27], v[30:31]
  v_cvt_pk_bf16_f32 v14, v24, v25
  v_cvt_pk_bf16_f32 v15, v26, v27
  s_add_u32 s31, s30, 2
  s_waitcnt lgkmcnt(2)
  v_mfma_f32_16x16x32_bf16 v[204:207], v[44:47], v[116:119], v[204:207]
  v_mfma_f32_16x16x32_bf16 v[220:223], v[44:47], v[180:183], v[220:223]
  s_lshr_b32 s32, s31, 1
  s_lshl_b32 s32, s32, 10
  s_and_b32 s33, s31, 1
  s_lshl_b32 s33, s33, 9
  s_add_u32 s32, s32, s33
  s_waitcnt lgkmcnt(1)
  v_mfma_f32_16x16x32_bf16 v[204:207], v[48:51], v[120:123], v[204:207]
  v_mfma_f32_16x16x32_bf16 v[220:223], v[48:51], v[184:187], v[220:223]
  s_add_u32 s32, s32, s28
  v_permlane16_swap_b32 v12, v14
  v_permlane16_swap_b32 v13, v15
  s_nop 0
  s_cmp_eq_u32 s69, 1
  s_cbranch_scc1 sdf_7
  buffer_store_dwordx4 v[12:15], v9, s[16:19], s32 offen sc1
  s_branch sde_7
sdf_7:
  buffer_store_dwordx4 v[12:15], v9, s[16:19], s32 offen
sde_7:
  s_waitcnt lgkmcnt(0)
  v_mfma_f32_16x16x32_bf16 v[204:207], v[52:55], v[124:127], v[204:207]
  v_mfma_f32_16x16x32_bf16 v[220:223], v[52:55], v[188:191], v[220:223]
  s_nop 1
  s_nop 15
  v_cvt_pk_bf16_f32 v20, v204, v205
  v_lshlrev_b32 v16, 16, v20
  v_and_b32 v17, 0xffff0000, v20
  v_cvt_pk_bf16_f32 v20, v206, v207
  v_lshlrev_b32 v18, 16, v20
  v_and_b32 v19, 0xffff0000, v20
  v_pk_mul_f32 v[20:21], v[16:17], s[40:41]
  v_pk_mul_f32 v[22:23], v[18:19], s[40:41]
  v_exp_f32 v20, v20
  v_exp_f32 v21, v21
  v_exp_f32 v22, v22
  v_exp_f32 v23, v23
  v_pk_add_f32 v[20:21], v[20:21], s[42:43]
  v_pk_add_f32 v[22:23], v[22:23], s[42:43]
  v_rcp_f32 v20, v20
  v_rcp_f32 v21, v21
  v_rcp_f32 v22, v22
  v_rcp_f32 v23, v23
  v_pk_mul_f32 v[16:17], v[16:17], v[20:21]
  v_pk_mul_f32 v[18:19], v[18:19], v[22:23]
  v_cvt_pk_bf16_f32 v12, v16, v17
  v_cvt_pk_bf16_f32 v13, v18, v19
  v_cvt_pk_bf16_f32 v28, v220, v221
  v_lshlrev_b32 v24, 16, v28
  v_and_b32 v25, 0xffff0000, v28
  v_cvt_pk_bf16_f32 v28, v222, v223
  v_lshlrev_b32 v26, 16, v28
  v_and_b32 v27, 0xffff0000, v28
  v_pk_mul_f32 v[28:29], v[24:25], s[40:41]
  v_pk_mul_f32 v[30:31], v[26:27], s[40:41]
  v_exp_f32 v28, v28
  v_exp_f32 v29, v29
  v_exp_f32 v30, v30
  v_exp_f32 v31, v31
  v_pk_add_f32 v[28:29], v[28:29], s[42:43]
  v_pk_add_f32 v[30:31], v[30:31], s[42:43]
  v_rcp_f32 v28, v28
  v_rcp_f32 v29, v29
  v_rcp_f32 v30, v30
  v_rcp_f32 v31, v31
  v_pk_mul_f32 v[24:25], v[24:25], v[28:29]
  v_pk_mul_f32 v[26:27], v[26:27], v[30:31]
  v_cvt_pk_bf16_f32 v14, v24, v25
  v_cvt_pk_bf16_f32 v15, v26, v27
  s_add_u32 s31, s30, 3
  s_lshr_b32 s32, s31, 1
  s_lshl_b32 s32, s32, 10
  s_and_b32 s33, s31, 1
  s_lshl_b32 s33, s33, 9
  s_add_u32 s32, s32, s33
  s_add_u32 s32, s32, s28
  v_permlane16_swap_b32 v12, v14
  v_permlane16_swap_b32 v13, v15
  s_nop 0
  s_cmp_eq_u32 s69, 1
  s_cbranch_scc1 sdf_8
  buffer_store_dwordx4 v[12:15], v9, s[16:19], s32 offen sc1
  s_branch sde_8
sdf_8:
  buffer_store_dwordx4 v[12:15], v9, s[16:19], s32 offen
sde_8:
  s_nop 1
  s_branch g1_end
g1_cg1:
  ds_read_b128 v[40:43], v7 offset:0
  ds_read_b128 v[44:47], v7 offset:7168
  ds_read_b128 v[48:51], v7 offset:14336
  ds_read_b128 v[52:55], v7 offset:21504
  ds_read_b128 v[56:59], v7 offset:28672
  ds_read_b128 v[60:63], v7 offset:35840
  s_waitcnt vmcnt(30) lgkmcnt(5)
  v_mfma_f32_16x16x32_bf16 v[192:195], v[40:43], v[64:67], v[192:195]
  v_mfma_f32_16x16x32_bf16 v[208:211], v[40:43], v[128:131], v[208:211]
  ds_read_b128 v[40:43], v7 offset:43008
  s_waitcnt vmcnt(28) lgkmcnt(5)
  v_mfma_f32_16x16x32_bf16 v[192:195], v[44:47], v[68:71], v[192:195]
  v_mfma_f32_16x16x32_bf16 v[208:211], v[44:47], v[132:135], v[208:211]
  ds_read_b128 v[44:47], v7 offset:50176
  s_waitcnt vmcnt(26) lgkmcnt(5)
  v_mfma_f32_16x16x32_bf16 v[192:195], v[48:51], v[72:75], v[192:195]
  v_mfma_f32_16x16x32_bf16 v[208:211], v[48:51], v[136:139], v[208:211]
  ds_read_b128 v[48:51], v8 offset:0
  s_waitcnt vmcnt(24) lgkmcnt(5)
  v_mfma_f32_16x16x32_bf16 v[192:195], v[52:55], v[76:79], v[192:195]
  v_mfma_f32_16x16x32_bf16 v[208:211], v[52:55], v[140:143], v[208:211]
  ds_read_b128 v[52:55], v8 offset:7168
  s_waitcnt vmcnt(22) lgkmcnt(5)
  v_mfma_f32_16x16x32_bf16 v[192:195], v[56:59], v[80:83], v[192:195]
  v_mfma_f32_16x16x32_bf16 v[208:211], v[56:59], v[144:147], v[208:211]
  ds_read_b128 v[56:59], v8 offset:14336
  s_waitcnt vmcnt(20) lgkmcnt(5)
  v_mfma_f32_16x16x32_bf16 v[192:195], v[60:63], v[84:87], v[192:195]
  v_mfma_f32_16x16x32_bf16 v[208:211], v[60:63], v[148:151], v[208:211]
  ds_read_b128 v[60:63], v8 offset:21504
  s_waitcnt vmcnt(18) lgkmcnt(5)
  v_mfma_f32_16x16x32_bf16 v[192:195], v[40:43], v[88:91], v[192:195]
  v_mfma_f32_16x16x32_bf16 v[208:211], v[40:43], v[152:155], v[208:211]
  ds_read_b128 v[40:43], v8 offset:28672
  s_waitcnt vmcnt(16) lgkmcnt(5)
  v_mfma_f32_16x16x32_bf16 v[192:195], v[44:47], v[92:95], v[192:195]
  v_mfma_f32_16x16x32_bf16 v[208:211], v[44:47], v[156:159], v[208:211]
  ds_read_b128 v[44:47], v8 offset:35840
  s_waitcnt vmcnt(14) lgkmcnt(5)
  v_mfma_f32_16x16x32_bf16 v[192:195], v[48:51], v[96:99], v[192:195]
  v_mfma_f32_16x16x32_bf16 v[208:211], v[48:51], v[160:163], v[208:211]
  ds_read_b128 v[48:51], v8 offset:43008
  s_waitcnt vmcnt(12) lgkmcnt(5)
  v_mfma_f32_16x16x32_bf16 v[192:195], v[52:55], v[100:103], v[192:195]
  v_mfma_f32_16x16x32_bf16 v[208:211], v[52:55], v[164:167], v[208:211]
  ds_read_b128 v[52:55], v8 offset:50176
  s_waitcnt vmcnt(10) lgkmcnt(5)
  v_mfma_f32_16x16x32_bf16 v[192:195], v[56:59], v[104:107], v[192:195]
  v_mfma_f32_16x16x32_bf16 v[208:211], v[56:59], v[168:171], v[208:211]
  ds_read_b128 v[56:59], v7 offset:1024
  s_waitcnt vmcnt(8) lgkmcnt(5)
  v_mfma_f32_16x16x32_bf16 v[192:195], v[60:63], v[108:111], v[192:195]
  v_mfma_f32_16x16x32_bf16 v[208:211], v[60:63], v[172:175], v[208:211]
  ds_read_b128 v[60:63], v7 offset:8192
  s_waitcnt vmcnt(6) lgkmcnt(5)
  v_mfma_f32_16x16x32_bf16 v[192:195], v[40:43], v[112:115], v[192:195]
  v_mfma_f32_16x16x32_bf16 v[208:211], v[40:43], v[176:179], v[208:211]
  ds_read_b128 v[40:43], v7 offset:15360
  s_waitcnt vmcnt(4) lgkmcnt(5)
  v_mfma_f32_16x16x32_bf16 v[192:195], v[44:47], v[116:119], v[192:195]
  v_mfma_f32_16x16x32_bf16 v[208:211], v[44:47], v[180:183], v[208:211]
  ds_read_b128 v[44:47], v7 offset:22528
  s_waitcnt vmcnt(2) lgkmcnt(5)
  v_mfma_f32_16x16x32_bf16 v[192:195], v[48:51], v[120:123], v[192:195]
  v_mfma_f32_16x16x32_bf16 v[208:211], v[48:51], v[184:187], v[208:211]
  ds_read_b128 v[48:51], v7 offset:29696
  s_waitcnt vmcnt(0) lgkmcnt(5)
  v_mfma_f32_16x16x32_bf16 v[192:195], v[52:55], v[124:127], v[192:195]
  v_mfma_f32_16x16x32_bf16 v[208:211], v[52:55], v[188:191], v[208:211]
  ds_read_b128 v[52:55], v7 offset:36864
  s_waitcnt lgkmcnt(5)
  v_mfma_f32_16x16x32_bf16 v[196:199], v[56:59], v[64:67], v[196:199]
  v_mfma_f32_16x16x32_bf16 v[212:215], v[56:59], v[128:131], v[212:215]
  ds_read_b128 v[56:59], v7 offset:44032
  s_waitcnt lgkmcnt(5)
  v_mfma_f32_16x16x32_bf16 v[196:199], v[60:63], v[68:71], v[196:199]
  v_mfma_f32_16x16x32_bf16 v[212:215], v[60:63], v[132:135], v[212:215]
  ds_read_b128 v[60:63], v7 offset:51200
  s_waitcnt lgkmcnt(5)
  v_mfma_f32_16x16x32_bf16 v[196:199], v[40:43], v[72:75], v[196:199]
  v_mfma_f32_16x16x32_bf16 v[212:215], v[40:43], v[136:139], v[212:215]
  ds_read_b128 v[40:43], v8 offset:1024
  s_waitcnt lgkmcnt(5)
  v_mfma_f32_16x16x32_bf16 v[196:199], v[44:47], v[76:79], v[196:199]
  v_mfma_f32_16x16x32_bf16 v[212:215], v[44:47], v[140:143], v[212:215]
  ds_read_b128 v[44:47], v8 offset:8192
  s_waitcnt lgkmcnt(5)
  v_mfma_f32_16x16x32_bf16 v[196:199], v[48:51], v[80:83], v[196:199]
  v_mfma_f32_16x16x32_bf16 v[212:215], v[48:51], v[144:147], v[212:215]
  v_cvt_pk_bf16_f32 v20, v192, v193
  v_lshlrev_b32 v16, 16, v20
  v_and_b32 v17, 0xffff0000, v20
  v_cvt_pk_bf16_f32 v20, v194, v195
  v_lshlrev_b32 v18, 16, v20
  ds_read_b128 v[48:51], v8 offset:15360
  s_waitcnt lgkmcnt(5)
  v_mfma_f32_16x16x32_bf16 v[196:199], v[52:55], v[84:87], v[196:199]
  v_mfma_f32_16x16x32_bf16 v[212:215], v[52:55], v[148:151], v[212:215]
  v_and_b32 v19, 0xffff0000, v20
  v_pk_mul_f32 v[20:21], v[16:17], s[40:41]
  v_pk_mul_f32 v[22:23], v[18:19], s[40:41]
  v_exp_f32 v20, v20
  v_exp_f32 v21, v21
  ds_read_b128 v[52:55], v8 offset:22528
  s_waitcnt lgkmcnt(5)
  v_mfma_f32_16x16x32_bf16 v[196:199], v[56:59], v[88:91], v[196:199]
  v_mfma_f32_16x16x32_bf16 v[212:215], v[56:59], v[152:155], v[212:215]
  v_exp_f32 v22, v22
  v_exp_f32 v23, v23
  v_pk_add_f32 v[20:21], v[20:21], s[42:43]
  v_pk_add_f32 v[22:23], v[22:23], s[42:43]
  v_rcp_f32 v20, v20
  ds_read_b128 v[56:59], v8 offset:29696
  s_waitcnt lgkmcnt(5)
  v_mfma_f32_16x16x32_bf16 v[196:199], v[60:63], v[92:95], v[196:199]
  v_mfma_f32_16x16x32_bf16 v[212:215], v[60:63], v[156:159], v[212:215]
  v_rcp_f32 v21, v21
  v_rcp_f32 v22, v22
  v_rcp_f32 v23, v23
  v_pk_mul_f32 v[16:17], v[16:17], v[20:21]
  v_pk_mul_f32 v[18:19], v[18:19], v[22:23]
  ds_read_b128 v[60:63], v8 offset:36864
  s_waitcnt lgkmcnt(5)
  v_mfma_f32_16x16x32_bf16 v[196:199], v[40:43], v[96:99], v[196:199]
  v_mfma_f32_16x16x32_bf16 v[212:215], v[40:43], v[160:163], v[212:215]
  v_cvt_pk_bf16_f32 v12, v16, v17
  v_cvt_pk_bf16_f32 v13, v18, v19
  v_cvt_pk_bf16_f32 v28, v208, v209
  v_lshlrev_b32 v24, 16, v28
  v_and_b32 v25, 0xffff0000, v28
  ds_read_b128 v[40:43], v8 offset:44032
  s_waitcnt lgkmcnt(5)
  v_mfma_f32_16x16x32_bf16 v[196:199], v[44:47], v[100:103], v[196:199]
  v_mfma_f32_16x16x32_bf16 v[212:215], v[44:47], v[164:167], v[212:215]
  v_cvt_pk_bf16_f32 v28, v210, v211
  v_lshlrev_b32 v26, 16, v28
  v_and_b32 v27, 0xffff0000, v28
  v_pk_mul_f32 v[28:29], v[24:25], s[40:41]
  v_pk_mul_f32 v[30:31], v[26:27], s[40:41]
  ds_read_b128 v[44:47], v8 offset:51200
  s_waitcnt lgkmcnt(5)
  v_mfma_f32_16x16x32_bf16 v[196:199], v[48:51], v[104:107], v[196:199]
  v_mfma_f32_16x16x32_bf16 v[212:215], v[48:51], v[168:171], v[212:215]
  v_exp_f32 v28, v28
  v_exp_f32 v29, v29
  v_exp_f32 v30, v30
  v_exp_f32 v31, v31
  v_pk_add_f32 v[28:29], v[28:29], s[42:43]
  ds_read_b128 v[48:51], v7 offset:2048
  s_waitcnt lgkmcnt(5)
  v_mfma_f32_16x16x32_bf16 v[196:199], v[52:55], v[108:111], v[196:199]
  v_mfma_f32_16x16x32_bf16 v[212:215], v[52:55], v[172:175], v[212:215]
  v_pk_add_f32 v[30:31], v[30:31], s[42:43]
  v_rcp_f32 v28, v28
  v_rcp_f32 v29, v29
  v_rcp_f32 v30, v30
  v_rcp_f32 v31, v31
  ds_read_b128 v[52:55], v7 offset:9216
  s_waitcnt lgkmcnt(5)
  v_mfma_f32_16x16x32_bf16 v[196:199], v[56:59], v[112:115], v[196:199]
  v_mfma_f32_16x16x32_bf16 v[212:215], v[56:59], v[176:179], v[212:215]
  v_pk_mul_f32 v[24:25], v[24:25], v[28:29]
  v_pk_mul_f32 v[26:27], v[26:27], v[30:31]
  v_cvt_pk_bf16_f32 v14, v24, v25
  v_cvt_pk_bf16_f32 v15, v26, v27
  s_add_u32 s31, s30, 0
  ds_read_b128 v[56:59], v7 offset:16384
  s_waitcnt lgkmcnt(5)
  v_mfma_f32_16x16x32_bf16 v[196:199], v[60:63], v[116:119], v[196:199]
  v_mfma_f32_16x16x32_bf16 v[212:215], v[60:63], v[180:183], v[212:215]
  s_lshr_b32 s32, s31, 1
  s_lshl_b32 s32, s32, 10
  s_and_b32 s33, s31, 1
  s_lshl_b32 s33, s33, 9
  s_add_u32 s32, s32, s33
  ds_read_b128 v[60:63], v7 offset:23552
  s_waitcnt lgkmcnt(5)
  v_mfma_f32_16x16x32_bf16 v[196:199], v[40:43], v[120:123], v[196:199]
  v_mfma_f32_16x16x32_bf16 v[212:215], v[40:43], v[184:187], v[212:215]
  s_add_u32 s32, s32, s28
  v_permlane16_swap_b32 v12, v14
  v_permlane16_swap_b32 v13, v15
  s_nop 0
  s_cmp_eq_u32 s69, 1
  s_cbranch_scc1 sdf_9
  buffer_store_dwordx4 v[12:15], v9, s[16:19], s32 offen sc1
  s_branch sde_9
sdf_9:
  buffer_store_dwordx4 v[12:15], v9, s[16:19], s32 offen
sde_9:
  ds_read_b128 v[40:43], v7 offset:30720
  s_waitcnt lgkmcnt(5)
  v_mfma_f32_16x16x32_bf16 v[196:199], v[44:47], v[124:127], v[196:199]
  v_mfma_f32_16x16x32_bf16 v[212:215], v[44:47], v[188:191], v[212:215]
  s_nop 1
  ds_read_b128 v[44:47], v7 offset:37888
  s_waitcnt lgkmcnt(5)
  v_mfma_f32_16x16x32_bf16 v[200:203], v[48:51], v[64:67], v[200:203]
  v_mfma_f32_16x16x32_bf16 v[216:219], v[48:51], v[128:131], v[216:219]
  ds_read_b128 v[48:51], v7 offset:45056
  s_waitcnt lgkmcnt(5)
  v_mfma_f32_16x16x32_bf16 v[200:203], v[52:55], v[68:71], v[200:203]
  v_mfma_f32_16x16x32_bf16 v[216:219], v[52:55], v[132:135], v[216:219]
  ds_read_b128 v[52:55], v7 offset:52224
  s_waitcnt lgkmcnt(5)
  v_mfma_f32_16x16x32_bf16 v[200:203], v[56:59], v[72:75], v[200:203]
  v_mfma_f32_16x16x32_bf16 v[216:219], v[56:59], v[136:139], v[216:219]
  ds_read_b128 v[56:59], v8 offset:2048
  s_waitcnt lgkmcnt(5)
  v_mfma_f32_16x16x32_bf16 v[200:203], v[60:63], v[76:79], v[200:203]
  v_mfma_f32_16x16x32_bf16 v[216:219], v[60:63], v[140:143], v[216:219]
  ds_read_b128 v[60:63], v8 offset:9216
  s_waitcnt lgkmcnt(5)
  v_mfma_f32_16x16x32_bf16 v[200:203], v[40:43], v[80:83], v[200:203]
  v_mfma_f32_16x16x32_bf16 v[216:219], v[40:43], v[144:147], v[216:219]
  v_cvt_pk_bf16_f32 v20, v196, v197
  v_lshlrev_b32 v16, 16, v20
  v_and_b32 v17, 0xffff0000, v20
  v_cvt_pk_bf16_f32 v20, v198, v199
  v_lshlrev_b32 v18, 16, v20
  ds_read_b128 v[40:43], v8 offset:16384
  s_waitcnt lgkmcnt(5)
  v_mfma_f32_16x16x32_bf16 v[200:203], v[44:47], v[84:87], v[200:203]
  v_mfma_f32_16x16x32_bf16 v[216:219], v[44:47], v[148:151], v[216:219]
  v_and_b32 v19, 0xffff0000, v20
  v_pk_mul_f32 v[20:21], v[16:17], s[40:41]
  v_pk_mul_f32 v[22:23], v[18:19], s[40:41]
  v_exp_f32 v20, v20
  v_exp_f32 v21, v21
  ds_read_b128 v[44:47], v8 offset:23552
  s_waitcnt lgkmcnt(5)
  v_mfma_f32_16x16x32_bf16 v[200:203], v[48:51], v[88:91], v[200:203]
  v_mfma_f32_16x16x32_bf16 v[216:219], v[48:51], v[152:155], v[216:219]
  v_exp_f32 v22, v22
  v_exp_f32 v23, v23
  v_pk_add_f32 v[20:21], v[20:21], s[42:43]
  v_pk_add_f32 v[22:23], v[22:23], s[42:43]
  v_rcp_f32 v20, v20
  ds_read_b128 v[48:51], v8 offset:30720
  s_waitcnt lgkmcnt(5)
  v_mfma_f32_16x16x32_bf16 v[200:203], v[52:55], v[92:95], v[200:203]
  v_mfma_f32_16x16x32_bf16 v[216:219], v[52:55], v[156:159], v[216:219]
  v_rcp_f32 v21, v21
  v_rcp_f32 v22, v22
  v_rcp_f32 v23, v23
  v_pk_mul_f32 v[16:17], v[16:17], v[20:21]
  v_pk_mul_f32 v[18:19], v[18:19], v[22:23]
  ds_read_b128 v[52:55], v8 offset:37888
  s_waitcnt lgkmcnt(5)
  v_mfma_f32_16x16x32_bf16 v[200:203], v[56:59], v[96:99], v[200:203]
  v_mfma_f32_16x16x32_bf16 v[216:219], v[56:59], v[160:163], v[216:219]
  v_cvt_pk_bf16_f32 v12, v16, v17
  v_cvt_pk_bf16_f32 v13, v18, v19
  v_cvt_pk_bf16_f32 v28, v212, v213
  v_lshlrev_b32 v24, 16, v28
  v_and_b32 v25, 0xffff0000, v28
  ds_read_b128 v[56:59], v8 offset:45056
  s_waitcnt lgkmcnt(5)
  v_mfma_f32_16x16x32_bf16 v[200:203], v[60:63], v[100:103], v[200:203]
  v_mfma_f32_16x16x32_bf16 v[216:219], v[60:63], v[164:167], v[216:219]
  v_cvt_pk_bf16_f32 v28, v214, v215
  v_lshlrev_b32 v26, 16, v28
  v_and_b32 v27, 0xffff0000, v28
  v_pk_mul_f32 v[28:29], v[24:25], s[40:41]
  v_pk_mul_f32 v[30:31], v[26:27], s[40:41]
  ds_read_b128 v[60:63], v8 offset:52224
  s_waitcnt lgkmcnt(5)
  v_mfma_f32_16x16x32_bf16 v[200:203], v[40:43], v[104:107], v[200:203]
  v_mfma_f32_16x16x32_bf16 v[216:219], v[40:43], v[168:171], v[216:219]
  v_exp_f32 v28, v28
  v_exp_f32 v29, v29
  v_exp_f32 v30, v30
  v_exp_f32 v31, v31
  v_pk_add_f32 v[28:29], v[28:29], s[42:43]
  s_waitcnt lgkmcnt(4)
  v_mfma_f32_16x16x32_bf16 v[200:203], v[44:47], v[108:111], v[200:203]
  v_mfma_f32_16x16x32_bf16 v[216:219], v[44:47], v[172:175], v[216:219]
  v_pk_add_f32 v[30:31], v[30:31], s[42:43]
  v_rcp_f32 v28, v28
  v_rcp_f32 v29, v29
  v_rcp_f32 v30, v30
  v_rcp_f32 v31, v31
  s_waitcnt lgkmcnt(3)
  v_mfma_f32_16x16x32_bf16 v[200:203], v[48:51], v[112:115], v[200:203]
  v_mfma_f32_16x16x32_bf16 v[216:219], v[48:51], v[176:179], v[216:219]
  v_pk_mul_f32 v[24:25], v[24:25], v[28:29]
  v_pk_mul_f32 v[26:27], v[26:27], v[30:31]
  v_cvt_pk_bf16_f32 v14, v24, v25
  v_cvt_pk_bf16_f32 v15, v26, v27
  s_add_u32 s31, s30, 1
  s_waitcnt lgkmcnt(2)
  v_mfma_f32_16x16x32_bf16 v[200:203], v[52:55], v[116:119], v[200:203]
  v_mfma_f32_16x16x32_bf16 v[216:219], v[52:55], v[180:183], v[216:219]
  s_lshr_b32 s32, s31, 1
  s_lshl_b32 s32, s32, 10
  s_and_b32 s33, s31, 1
  s_lshl_b32 s33, s33, 9
  s_add_u32 s32, s32, s33
  s_waitcnt lgkmcnt(1)
  v_mfma_f32_16x16x32_bf16 v[200:203], v[56:59], v[120:123], v[200:203]
  v_mfma_f32_16x16x32_bf16 v[216:219], v[56:59], v[184:187], v[216:219]
  s_add_u32 s32, s32, s28
  v_permlane16_swap_b32 v12, v14
  v_permlane16_swap_b32 v13, v15
  s_nop 0
  s_cmp_eq_u32 s69, 1
  s_cbranch_scc1 sdf_10
  buffer_store_dwordx4 v[12:15], v9, s[16:19], s32 offen sc1
  s_branch sde_10
sdf_10:
  buffer_store_dwordx4 v[12:15], v9, s[16:19], s32 offen
sde_10:
  s_waitcnt lgkmcnt(0)
  v_mfma_f32_16x16x32_bf16 v[200:203], v[60:63], v[124:127], v[200:203]
  v_mfma_f32_16x16x32_bf16 v[216:219], v[60:63], v[188:191], v[216:219]
  s_nop 1
  s_nop 15
  v_cvt_pk_bf16_f32 v20, v200, v201
  v_lshlrev_b32 v16, 16, v20
  v_and_b32 v17, 0xffff0000, v20
  v_cvt_pk_bf16_f32 v20, v202, v203
  v_lshlrev_b32 v18, 16, v20
  v_and_b32 v19, 0xffff0000, v20
  v_pk_mul_f32 v[20:21], v[16:17], s[40:41]
  v_pk_mul_f32 v[22:23], v[18:19], s[40:41]
  v_exp_f32 v20, v20
  v_exp_f32 v21, v21
  v_exp_f32 v22, v22
  v_exp_f32 v23, v23
  v_pk_add_f32 v[20:21], v[20:21], s[42:43]
  v_pk_add_f32 v[22:23], v[22:23], s[42:43]
  v_rcp_f32 v20, v20
  v_rcp_f32 v21, v21
  v_rcp_f32 v22, v22
  v_rcp_f32 v23, v23
  v_pk_mul_f32 v[16:17], v[16:17], v[20:21]
  v_pk_mul_f32 v[18:19], v[18:19], v[22:23]
  v_cvt_pk_bf16_f32 v12, v16, v17
  v_cvt_pk_bf16_f32 v13, v18, v19
  v_cvt_pk_bf16_f32 v28, v216, v217
  v_lshlrev_b32 v24, 16, v28
  v_and_b32 v25, 0xffff0000, v28
  v_cvt_pk_bf16_f32 v28, v218, v219
  v_lshlrev_b32 v26, 16, v28
  v_and_b32 v27, 0xffff0000, v28
  v_pk_mul_f32 v[28:29], v[24:25], s[40:41]
  v_pk_mul_f32 v[30:31], v[26:27], s[40:41]
  v_exp_f32 v28, v28
  v_exp_f32 v29, v29
  v_exp_f32 v30, v30
  v_exp_f32 v31, v31
  v_pk_add_f32 v[28:29], v[28:29], s[42:43]
  v_pk_add_f32 v[30:31], v[30:31], s[42:43]
  v_rcp_f32 v28, v28
  v_rcp_f32 v29, v29
  v_rcp_f32 v30, v30
  v_rcp_f32 v31, v31
  v_pk_mul_f32 v[24:25], v[24:25], v[28:29]
  v_pk_mul_f32 v[26:27], v[26:27], v[30:31]
  v_cvt_pk_bf16_f32 v14, v24, v25
  v_cvt_pk_bf16_f32 v15, v26, v27
  s_add_u32 s31, s30, 2
  s_lshr_b32 s32, s31, 1
  s_lshl_b32 s32, s32, 10
  s_and_b32 s33, s31, 1
  s_lshl_b32 s33, s33, 9
  s_add_u32 s32, s32, s33
  s_add_u32 s32, s32, s28
  v_permlane16_swap_b32 v12, v14
  v_permlane16_swap_b32 v13, v15
  s_nop 0
  s_cmp_eq_u32 s69, 1
  s_cbranch_scc1 sdf_11
  buffer_store_dwordx4 v[12:15], v9, s[16:19], s32 offen sc1
  s_branch sde_11
sdf_11:
  buffer_store_dwordx4 v[12:15], v9, s[16:19], s32 offen
sde_11:
  s_nop 1
g1_end:
  s_load_dwordx2 s[6:7], s[0:1], 64
  s_bfe_u32 s20, s71, 0x30002
  s_lshr_b32 s21, s71, 5
  s_lshl_b32 s21, s21, 2
  s_and_b32 s22, s71, 3
  s_add_u32 s21, s21, s22
  v_and_b32 v2, 63, v0
  v_and_b32 v3, 15, v0
  v_bfe_u32 v4, v0, 4, 2
  s_waitcnt lgkmcnt(0)
  s_add_u32 s8, s4, 0x1190000
  s_addc_u32 s9, s5, 0
  s_mov_b32 s10, 0x700000
  s_mov_b32 s11, 0x00020000
  s_add_u32 s12, s4, 0x3d0000
  s_addc_u32 s13, s5, 0
  s_mov_b32 s14, 0x1c0000
  s_mov_b32 s15, 0x00020000
  s_mov_b32 s16, s6
  s_mov_b32 s17, s7
  s_mov_b32 s18, 0x200000
  s_mov_b32 s19, 0x00020000
  s_add_u32 s80, s4, 0xd90000
  s_addc_u32 s81, s5, 0
  s_mov_b32 s82, 0x200000
  s_mov_b32 s83, 0x00020000
  s_mov_b32 s84, s4
  s_mov_b32 s85, s5
  s_mov_b32 s86, 0x3000
  s_mov_b32 s87, 0x00020000
  v_lshlrev_b32 v7, 4, v2
  s_mul_i32 s23, s95, 7
  s_mul_i32 s24, s20, 56
  s_add_u32 s24, s24, s23
  s_lshl_b32 s24, s24, 12
  s_lshl_b32 s32, s21, 2
  s_add_u32 s32, s32, 0
  s_mul_i32 s32, s32, 56
  s_add_u32 s32, s32, s23
  s_lshl_b32 s32, s32, 10
  s_lshl_b32 s33, s21, 2
  s_add_u32 s33, s33, 1
  s_mul_i32 s33, s33, 56
  s_add_u32 s33, s33, s23
  s_lshl_b32 s33, s33, 10
  s_lshl_b32 s34, s21, 2
  s_add_u32 s34, s34, 2
  s_mul_i32 s34, s34, 56
  s_add_u32 s34, s34, s23
  s_lshl_b32 s34, s34, 10
  s_lshl_b32 s35, s21, 2
  s_add_u32 s35, s35, 3
  s_mul_i32 s35, s35, 56
  s_add_u32 s35, s35, s23
  s_lshl_b32 s35, s35, 10
  buffer_load_dwordx4 v[80:83], v7, s[12:15], s24 offen offset:0
  buffer_load_dwordx4 v[84:87], v7, s[12:15], s24 offen offset:1024
  buffer_load_dwordx4 v[88:91], v7, s[12:15], s24 offen offset:2048
  buffer_load_dwordx4 v[92:95], v7, s[12:15], s24 offen offset:3072
  s_add_u32 s24, s24, 4096
  buffer_load_dwordx4 v[96:99], v7, s[12:15], s24 offen offset:0
  buffer_load_dwordx4 v[100:103], v7, s[12:15], s24 offen offset:1024
  buffer_load_dwordx4 v[104:107], v7, s[12:15], s24 offen offset:2048
  buffer_load_dwordx4 v[108:111], v7, s[12:15], s24 offen offset:3072
  s_add_u32 s24, s24, 4096
  buffer_load_dwordx4 v[112:115], v7, s[12:15], s24 offen offset:0
  buffer_load_dwordx4 v[116:119], v7, s[12:15], s24 offen offset:1024
  buffer_load_dwordx4 v[120:123], v7, s[12:15], s24 offen offset:2048
  buffer_load_dwordx4 v[124:127], v7, s[12:15], s24 offen offset:3072
  s_add_u32 s24, s24, 4096
  buffer_load_dwordx4 v[128:131], v7, s[12:15], s24 offen offset:0
  buffer_load_dwordx4 v[132:135], v7, s[12:15], s24 offen offset:1024
  buffer_load_dwordx4 v[136:139], v7, s[12:15], s24 offen offset:2048
  buffer_load_dwordx4 v[140:143], v7, s[12:15], s24 offen offset:3072
  s_add_u32 s24, s24, 4096
  buffer_load_dwordx4 v[144:147], v7, s[12:15], s24 offen offset:0
  buffer_load_dwordx4 v[148:151], v7, s[12:15], s24 offen offset:1024
  buffer_load_dwordx4 v[152:155], v7, s[12:15], s24 offen offset:2048
  buffer_load_dwordx4 v[156:159], v7, s[12:15], s24 offen offset:3072
  s_add_u32 s24, s24, 4096
  buffer_load_dwordx4 v[160:163], v7, s[12:15], s24 offen offset:0
  buffer_load_dwordx4 v[164:167], v7, s[12:15], s24 offen offset:1024
  buffer_load_dwordx4 v[168:171], v7, s[12:15], s24 offen offset:2048
  buffer_load_dwordx4 v[172:175], v7, s[12:15], s24 offen offset:3072
  s_add_u32 s24, s24, 4096
  buffer_load_dwordx4 v[176:179], v7, s[12:15], s24 offen offset:0
  buffer_load_dwordx4 v[180:183], v7, s[12:15], s24 offen offset:1024
  buffer_load_dwordx4 v[184:187], v7, s[12:15], s24 offen offset:2048
  buffer_load_dwordx4 v[188:191], v7, s[12:15], s24 offen offset:3072
  s_add_u32 s24, s24, 4096
  s_waitcnt vmcnt(28) lgkmcnt(0)
  s_barrier
  s_cmp_lg_u32 s95, 0
  s_cbranch_scc1 arr_skip_e
  s_mov_b64 s[92:93], exec
  s_mov_b64 exec, 1
  s_lshl_b32 s94, s71, 6
  v_mov_b32 v255, s94
  v_mov_b32 v254, 5
  s_cmp_eq_u32 s69, 1
  s_cbranch_scc1 sdf_12
  buffer_store_dword v254, v255, s[64:67], 0 offen sc1
  s_branch sde_12
sdf_12:
  buffer_store_dword v254, v255, s[64:67], 0 offen
sde_12:
  s_mov_b64 exec, s[92:93]
arr_skip_e:
  v_mov_b32 v16, 0
  v_mov_b32 v17, 0
  v_mov_b32 v18, 0
  v_mov_b32 v19, 0
  v_mov_b32 v20, 0
  v_mov_b32 v21, 0
  v_mov_b32 v22, 0
  v_mov_b32 v23, 0
  v_mov_b32 v24, 0
  v_mov_b32 v25, 0
  v_mov_b32 v26, 0
  v_mov_b32 v27, 0
  v_mov_b32 v28, 0
  v_mov_b32 v29, 0
  v_mov_b32 v30, 0
  v_mov_b32 v31, 0
  v_mov_b32 v32, 0
  v_mov_b32 v33, 0
  v_mov_b32 v34, 0
  v_mov_b32 v35, 0
  v_mov_b32 v36, 0
  v_mov_b32 v37, 0
  v_mov_b32 v38, 0
  v_mov_b32 v39, 0
  v_mov_b32 v40, 0
  v_mov_b32 v41, 0
  v_mov_b32 v42, 0
  v_mov_b32 v43, 0
  v_mov_b32 v44, 0
  v_mov_b32 v45, 0
  v_mov_b32 v46, 0
  v_mov_b32 v47, 0
  v_mov_b32 v48, 0
  v_mov_b32 v49, 0
  v_mov_b32 v50, 0
  v_mov_b32 v51, 0
  v_mov_b32 v52, 0
  v_mov_b32 v53, 0
  v_mov_b32 v54, 0
  v_mov_b32 v55, 0
  v_mov_b32 v56, 0
  v_mov_b32 v57, 0
  v_mov_b32 v58, 0
  v_mov_b32 v59, 0
  v_mov_b32 v60, 0
  v_mov_b32 v61, 0
  v_mov_b32 v62, 0
  v_mov_b32 v63, 0
  v_mov_b32 v64, 0
  v_mov_b32 v65, 0
  v_mov_b32 v66, 0
  v_mov_b32 v67, 0
  v_mov_b32 v68, 0
  v_mov_b32 v69, 0
  v_mov_b32 v70, 0
  v_mov_b32 v71, 0
  v_mov_b32 v72, 0
  v_mov_b32 v73, 0
  v_mov_b32 v74, 0
  v_mov_b32 v75, 0
  v_mov_b32 v76, 0
  v_mov_b32 v77, 0
  v_mov_b32 v78, 0
  v_mov_b32 v79, 0
  s_waitcnt vmcnt(0)
  s_cmp_lg_u32 s95, 0
  s_cbranch_scc1 wait_skip_e
  v_and_b32 v253, 63, v0
  v_lshlrev_b32 v253, 6, v253
  s_cmp_eq_u32 s69, 1
  s_cbranch_scc0 wait_loop_e
  s_lshr_b32 s94, s71, 5
  s_lshl_b32 s94, s94, 11
  s_mov_b64 s[92:93], exec
  s_mov_b64 exec, 0xffffffff
wait_floop_e:
  buffer_load_dword v254, v253, s[64:67], s94 offen sc1
  s_waitcnt vmcnt(0)
  v_cmp_gt_u32 vcc, 5, v254
  s_cmp_eq_u64 vcc, 0
  s_cbranch_scc0 wait_floop_e
  s_mov_b64 exec, s[92:93]
  s_branch wait_skip_e
wait_loop_e:
  s_movk_i32 s94, 0
  buffer_load_dword v249, v253, s[64:67], s94 offen sc1
  s_movk_i32 s94, 4096
  buffer_load_dword v250, v253, s[64:67], s94 offen sc1
  s_movk_i32 s94, 8192
  buffer_load_dword v251, v253, s[64:67], s94 offen sc1
  s_movk_i32 s94, 12288
  buffer_load_dword v252, v253, s[64:67], s94 offen sc1
  s_waitcnt vmcnt(0)
  v_min_u32 v249, v249, v250
  v_min_u32 v251, v251, v252
  v_min_u32 v249, v249, v251
  v_cmp_gt_u32 vcc, 5, v249
  s_cmp_eq_u64 vcc, 0
  s_cbranch_scc1 wait_skip_e
  s_sleep 3
  s_branch wait_loop_e
wait_skip_e:
  s_barrier
  buffer_load_dwordx4 v[192:195], v7, s[8:11], s32 offen
  s_add_u32 s32, s32, 1024
  buffer_load_dwordx4 v[196:199], v7, s[8:11], s33 offen
  s_add_u32 s33, s33, 1024
  buffer_load_dwordx4 v[200:203], v7, s[8:11], s34 offen
  s_add_u32 s34, s34, 1024
  buffer_load_dwordx4 v[204:207], v7, s[8:11], s35 offen
  s_add_u32 s35, s35, 1024
  buffer_load_dwordx4 v[208:211], v7, s[8:11], s32 offen
  s_add_u32 s32, s32, 1024
  buffer_load_dwordx4 v[212:215], v7, s[8:11], s33 offen
  s_add_u32 s33, s33, 1024
  buffer_load_dwordx4 v[216:219], v7, s[8:11], s34 offen
  s_add_u32 s34, s34, 1024
  buffer_load_dwordx4 v[220:223], v7, s[8:11], s35 offen
  s_add_u32 s35, s35, 1024
  buffer_load_dwordx4 v[224:227], v7, s[8:11], s32 offen
  s_add_u32 s32, s32, 1024
  buffer_load_dwordx4 v[228:231], v7, s[8:11], s33 offen
  s_add_u32 s33, s33, 1024
  buffer_load_dwordx4 v[232:235], v7, s[8:11], s34 offen
  s_add_u32 s34, s34, 1024
  buffer_load_dwordx4 v[236:239], v7, s[8:11], s35 offen
  s_add_u32 s35, s35, 1024
  s_waitcnt vmcnt(8)
  v_mfma_f32_16x16x32_bf16 v[16:19], v[80:83], v[192:195], v[16:19]
  v_mfma_f32_16x16x32_bf16 v[20:23], v[84:87], v[192:195], v[20:23]
  v_mfma_f32_16x16x32_bf16 v[24:27], v[88:91], v[192:195], v[24:27]
  v_mfma_f32_16x16x32_bf16 v[28:31], v[92:95], v[192:195], v[28:31]
  v_mfma_f32_16x16x32_bf16 v[32:35], v[80:83], v[196:199], v[32:35]
  v_mfma_f32_16x16x32_bf16 v[36:39], v[84:87], v[196:199], v[36:39]
  v_mfma_f32_16x16x32_bf16 v[40:43], v[88:91], v[196:199], v[40:43]
  v_mfma_f32_16x16x32_bf16 v[44:47], v[92:95], v[196:199], v[44:47]
  v_mfma_f32_16x16x32_bf16 v[48:51], v[80:83], v[200:203], v[48:51]
  v_mfma_f32_16x16x32_bf16 v[52:55], v[84:87], v[200:203], v[52:55]
  v_mfma_f32_16x16x32_bf16 v[56:59], v[88:91], v[200:203], v[56:59]
  v_mfma_f32_16x16x32_bf16 v[60:63], v[92:95], v[200:203], v[60:63]
  v_mfma_f32_16x16x32_bf16 v[64:67], v[80:83], v[204:207], v[64:67]
  v_mfma_f32_16x16x32_bf16 v[68:71], v[84:87], v[204:207], v[68:71]
  v_mfma_f32_16x16x32_bf16 v[72:75], v[88:91], v[204:207], v[72:75]
  v_mfma_f32_16x16x32_bf16 v[76:79], v[92:95], v[204:207], v[76:79]
  buffer_load_dwordx4 v[192:195], v7, s[8:11], s32 offen
  s_add_u32 s32, s32, 1024
  buffer_load_dwordx4 v[196:199], v7, s[8:11], s33 offen
  s_add_u32 s33, s33, 1024
  buffer_load_dwordx4 v[200:203], v7, s[8:11], s34 offen
  s_add_u32 s34, s34, 1024
  buffer_load_dwordx4 v[204:207], v7, s[8:11], s35 offen
  s_add_u32 s35, s35, 1024
  s_waitcnt vmcnt(8)
  v_mfma_f32_16x16x32_bf16 v[16:19], v[96:99], v[208:211], v[16:19]
  v_mfma_f32_16x16x32_bf16 v[20:23], v[100:103], v[208:211], v[20:23]
  v_mfma_f32_16x16x32_bf16 v[24:27], v[104:107], v[208:211], v[24:27]
  v_mfma_f32_16x16x32_bf16 v[28:31], v[108:111], v[208:211], v[28:31]
  v_mfma_f32_16x16x32_bf16 v[32:35], v[96:99], v[212:215], v[32:35]
  v_mfma_f32_16x16x32_bf16 v[36:39], v[100:103], v[212:215], v[36:39]
  v_mfma_f32_16x16x32_bf16 v[40:43], v[104:107], v[212:215], v[40:43]
  v_mfma_f32_16x16x32_bf16 v[44:47], v[108:111], v[212:215], v[44:47]
  v_mfma_f32_16x16x32_bf16 v[48:51], v[96:99], v[216:219], v[48:51]
  v_mfma_f32_16x16x32_bf16 v[52:55], v[100:103], v[216:219], v[52:55]
  v_mfma_f32_16x16x32_bf16 v[56:59], v[104:107], v[216:219], v[56:59]
  v_mfma_f32_16x16x32_bf16 v[60:63], v[108:111], v[216:219], v[60:63]
  v_mfma_f32_16x16x32_bf16 v[64:67], v[96:99], v[220:223], v[64:67]
  v_mfma_f32_16x16x32_bf16 v[68:71], v[100:103], v[220:223], v[68:71]
  v_mfma_f32_16x16x32_bf16 v[72:75], v[104:107], v[220:223], v[72:75]
  v_mfma_f32_16x16x32_bf16 v[76:79], v[108:111], v[220:223], v[76:79]
  buffer_load_dwordx4 v[208:211], v7, s[8:11], s32 offen
  s_add_u32 s32, s32, 1024
  buffer_load_dwordx4 v[212:215], v7, s[8:11], s33 offen
  s_add_u32 s33, s33, 1024
  buffer_load_dwordx4 v[216:219], v7, s[8:11], s34 offen
  s_add_u32 s34, s34, 1024
  buffer_load_dwordx4 v[220:223], v7, s[8:11], s35 offen
  s_add_u32 s35, s35, 1024
  s_waitcnt vmcnt(8)
  v_mfma_f32_16x16x32_bf16 v[16:19], v[112:115], v[224:227], v[16:19]
  v_mfma_f32_16x16x32_bf16 v[20:23], v[116:119], v[224:227], v[20:23]
  v_mfma_f32_16x16x32_bf16 v[24:27], v[120:123], v[224:227], v[24:27]
  v_mfma_f32_16x16x32_bf16 v[28:31], v[124:127], v[224:227], v[28:31]
  v_mfma_f32_16x16x32_bf16 v[32:35], v[112:115], v[228:231], v[32:35]
  v_mfma_f32_16x16x32_bf16 v[36:39], v[116:119], v[228:231], v[36:39]
  v_mfma_f32_16x16x32_bf16 v[40:43], v[120:123], v[228:231], v[40:43]
  v_mfma_f32_16x16x32_bf16 v[44:47], v[124:127], v[228:231], v[44:47]
  v_mfma_f32_16x16x32_bf16 v[48:51], v[112:115], v[232:235], v[48:51]
  v_mfma_f32_16x16x32_bf16 v[52:55], v[116:119], v[232:235], v[52:55]
  v_mfma_f32_16x16x32_bf16 v[56:59], v[120:123], v[232:235], v[56:59]
  v_mfma_f32_16x16x32_bf16 v[60:63], v[124:127], v[232:235], v[60:63]
  v_mfma_f32_16x16x32_bf16 v[64:67], v[112:115], v[236:239], v[64:67]
  v_mfma_f32_16x16x32_bf16 v[68:71], v[116:119], v[236:239], v[68:71]
  v_mfma_f32_16x16x32_bf16 v[72:75], v[120:123], v[236:239], v[72:75]
  v_mfma_f32_16x16x32_bf16 v[76:79], v[124:127], v[236:239], v[76:79]
  buffer_load_dwordx4 v[224:227], v7, s[8:11], s32 offen
  s_add_u32 s32, s32, 1024
  buffer_load_dwordx4 v[228:231], v7, s[8:11], s33 offen
  s_add_u32 s33, s33, 1024
  buffer_load_dwordx4 v[232:235], v7, s[8:11], s34 offen
  s_add_u32 s34, s34, 1024
  buffer_load_dwordx4 v[236:239], v7, s[8:11], s35 offen
  s_add_u32 s35, s35, 1024
  s_waitcnt vmcnt(8)
  v_mfma_f32_16x16x32_bf16 v[16:19], v[128:131], v[192:195], v[16:19]
  v_mfma_f32_16x16x32_bf16 v[20:23], v[132:135], v[192:195], v[20:23]
  v_mfma_f32_16x16x32_bf16 v[24:27], v[136:139], v[192:195], v[24:27]
  v_mfma_f32_16x16x32_bf16 v[28:31], v[140:143], v[192:195], v[28:31]
  v_mfma_f32_16x16x32_bf16 v[32:35], v[128:131], v[196:199], v[32:35]
  v_mfma_f32_16x16x32_bf16 v[36:39], v[132:135], v[196:199], v[36:39]
  v_mfma_f32_16x16x32_bf16 v[40:43], v[136:139], v[196:199], v[40:43]
  v_mfma_f32_16x16x32_bf16 v[44:47], v[140:143], v[196:199], v[44:47]
  v_mfma_f32_16x16x32_bf16 v[48:51], v[128:131], v[200:203], v[48:51]
  v_mfma_f32_16x16x32_bf16 v[52:55], v[132:135], v[200:203], v[52:55]
  v_mfma_f32_16x16x32_bf16 v[56:59], v[136:139], v[200:203], v[56:59]
  v_mfma_f32_16x16x32_bf16 v[60:63], v[140:143], v[200:203], v[60:63]
  v_mfma_f32_16x16x32_bf16 v[64:67], v[128:131], v[204:207], v[64:67]
  v_mfma_f32_16x16x32_bf16 v[68:71], v[132:135], v[204:207], v[68:71]
  v_mfma_f32_16x16x32_bf16 v[72:75], v[136:139], v[204:207], v[72:75]
  v_mfma_f32_16x16x32_bf16 v[76:79], v[140:143], v[204:207], v[76:79]
  buffer_load_dwordx4 v[192:195], v7, s[8:11], s32 offen
  s_add_u32 s32, s32, 1024
  buffer_load_dwordx4 v[196:199], v7, s[8:11], s33 offen
  s_add_u32 s33, s33, 1024
  buffer_load_dwordx4 v[200:203], v7, s[8:11], s34 offen
  s_add_u32 s34, s34, 1024
  buffer_load_dwordx4 v[204:207], v7, s[8:11], s35 offen
  s_add_u32 s35, s35, 1024
  s_waitcnt vmcnt(8)
  v_mfma_f32_16x16x32_bf16 v[16:19], v[144:147], v[208:211], v[16:19]
  v_mfma_f32_16x16x32_bf16 v[20:23], v[148:151], v[208:211], v[20:23]
  v_mfma_f32_16x16x32_bf16 v[24:27], v[152:155], v[208:211], v[24:27]
  v_mfma_f32_16x16x32_bf16 v[28:31], v[156:159], v[208:211], v[28:31]
  v_mfma_f32_16x16x32_bf16 v[32:35], v[144:147], v[212:215], v[32:35]
  v_mfma_f32_16x16x32_bf16 v[36:39], v[148:151], v[212:215], v[36:39]
  v_mfma_f32_16x16x32_bf16 v[40:43], v[152:155], v[212:215], v[40:43]
  v_mfma_f32_16x16x32_bf16 v[44:47], v[156:159], v[212:215], v[44:47]
  v_mfma_f32_16x16x32_bf16 v[48:51], v[144:147], v[216:219], v[48:51]
  v_mfma_f32_16x16x32_bf16 v[52:55], v[148:151], v[216:219], v[52:55]
  v_mfma_f32_16x16x32_bf16 v[56:59], v[152:155], v[216:219], v[56:59]
  v_mfma_f32_16x16x32_bf16 v[60:63], v[156:159], v[216:219], v[60:63]
  v_mfma_f32_16x16x32_bf16 v[64:67], v[144:147], v[220:223], v[64:67]
  v_mfma_f32_16x16x32_bf16 v[68:71], v[148:151], v[220:223], v[68:71]
  v_mfma_f32_16x16x32_bf16 v[72:75], v[152:155], v[220:223], v[72:75]
  v_mfma_f32_16x16x32_bf16 v[76:79], v[156:159], v[220:223], v[76:79]
  s_waitcnt vmcnt(4)
  v_mfma_f32_16x16x32_bf16 v[16:19], v[160:163], v[224:227], v[16:19]
  v_mfma_f32_16x16x32_bf16 v[20:23], v[164:167], v[224:227], v[20:23]
  v_mfma_f32_16x16x32_bf16 v[24:27], v[168:171], v[224:227], v[24:27]
  v_mfma_f32_16x16x32_bf16 v[28:31], v[172:175], v[224:227], v[28:31]
  v_mfma_f32_16x16x32_bf16 v[32:35], v[160:163], v[228:231], v[32:35]
  v_mfma_f32_16x16x32_bf16 v[36:39], v[164:167], v[228:231], v[36:39]
  v_mfma_f32_16x16x32_bf16 v[40:43], v[168:171], v[228:231], v[40:43]
  v_mfma_f32_16x16x32_bf16 v[44:47], v[172:175], v[228:231], v[44:47]
  v_mfma_f32_16x16x32_bf16 v[48:51], v[160:163], v[232:235], v[48:51]
  v_mfma_f32_16x16x32_bf16 v[52:55], v[164:167], v[232:235], v[52:55]
  v_mfma_f32_16x16x32_bf16 v[56:59], v[168:171], v[232:235], v[56:59]
  v_mfma_f32_16x16x32_bf16 v[60:63], v[172:175], v[232:235], v[60:63]
  v_mfma_f32_16x16x32_bf16 v[64:67], v[160:163], v[236:239], v[64:67]
  v_mfma_f32_16x16x32_bf16 v[68:71], v[164:167], v[236:239], v[68:71]
  v_mfma_f32_16x16x32_bf16 v[72:75], v[168:171], v[236:239], v[72:75]
  v_mfma_f32_16x16x32_bf16 v[76:79], v[172:175], v[236:239], v[76:79]
  s_waitcnt vmcnt(0)
  v_mfma_f32_16x16x32_bf16 v[16:19], v[176:179], v[192:195], v[16:19]
  v_mfma_f32_16x16x32_bf16 v[20:23], v[180:183], v[192:195], v[20:23]
  v_mfma_f32_16x16x32_bf16 v[24:27], v[184:187], v[192:195], v[24:27]
  v_mfma_f32_16x16x32_bf16 v[28:31], v[188:191], v[192:195], v[28:31]
  v_mfma_f32_16x16x32_bf16 v[32:35], v[176:179], v[196:199], v[32:35]
  v_mfma_f32_16x16x32_bf16 v[36:39], v[180:183], v[196:199], v[36:39]
  v_mfma_f32_16x16x32_bf16 v[40:43], v[184:187], v[196:199], v[40:43]
  v_mfma_f32_16x16x32_bf16 v[44:47], v[188:191], v[196:199], v[44:47]
  v_mfma_f32_16x16x32_bf16 v[48:51], v[176:179], v[200:203], v[48:51]
  v_mfma_f32_16x16x32_bf16 v[52:55], v[180:183], v[200:203], v[52:55]
  v_mfma_f32_16x16x32_bf16 v[56:59], v[184:187], v[200:203], v[56:59]
  v_mfma_f32_16x16x32_bf16 v[60:63], v[188:191], v[200:203], v[60:63]
  v_mfma_f32_16x16x32_bf16 v[64:67], v[176:179], v[204:207], v[64:67]
  v_mfma_f32_16x16x32_bf16 v[68:71], v[180:183], v[204:207], v[68:71]
  v_mfma_f32_16x16x32_bf16 v[72:75], v[184:187], v[204:207], v[72:75]
  v_mfma_f32_16x16x32_bf16 v[76:79], v[188:191], v[204:207], v[76:79]
  s_lshr_b32 s25, s95, 1
  s_and_b32 s26, s95, 1
  s_lshl_b32 s27, s20, 7
  v_lshl_add_u32 v11, v4, 3, s27
  s_lshl_b32 s31, s26, 6
  v_add_u32 v11, s31, v11
  v_lshlrev_b32 v12, 1, v11
  s_movk_i32 s28, 10240
  s_lshl_b32 s30, s21, 6
  s_lshl_b32 s31, s25, 4
  s_add_u32 s30, s30, s31
  v_add_u32 v10, s30, v3
  v_lshlrev_b32 v10, 10, v10
  v_add_u32 v10, v10, v11
  buffer_load_dwordx4 v[80:83], v12, s[84:87], s28 offen offset:0
  buffer_load_dwordx2 v[88:89], v10, s[80:83], 0 offen offset:0
  buffer_load_dwordx4 v[84:87], v12, s[84:87], s28 offen offset:64
  buffer_load_dwordx2 v[90:91], v10, s[80:83], 0 offen offset:32
  s_nop 7
  s_lshl_b32 s29, s95, 14
  v_add_u32 v8, s29, v7
  ds_write_b128 v8, v[16:19] offset:0
  ds_write_b128 v8, v[20:23] offset:1024
  ds_write_b128 v8, v[24:27] offset:2048
  ds_write_b128 v8, v[28:31] offset:3072
  ds_write_b128 v8, v[32:35] offset:4096
  ds_write_b128 v8, v[36:39] offset:5120
  ds_write_b128 v8, v[40:43] offset:6144
  ds_write_b128 v8, v[44:47] offset:7168
  ds_write_b128 v8, v[48:51] offset:8192
  ds_write_b128 v8, v[52:55] offset:9216
  ds_write_b128 v8, v[56:59] offset:10240
  ds_write_b128 v8, v[60:63] offset:11264
  ds_write_b128 v8, v[64:67] offset:12288
  ds_write_b128 v8, v[68:71] offset:13312
  ds_write_b128 v8, v[72:75] offset:14336
  ds_write_b128 v8, v[76:79] offset:15360
  s_waitcnt lgkmcnt(0)
  s_barrier
  s_lshl_b32 s27, s25, 12
  s_lshl_b32 s29, s26, 11
  s_add_u32 s27, s27, s29
  v_add_u32 v8, s27, v7
  v_add_u32 v9, 65536, v8
  ds_read_b128 v[96:99], v8 offset:0
  ds_read_b128 v[100:103], v8 offset:1024
  ds_read_b128 v[104:107], v8 offset:16384
  ds_read_b128 v[108:111], v8 offset:17408
  ds_read_b128 v[112:115], v8 offset:32768
  ds_read_b128 v[116:119], v8 offset:33792
  ds_read_b128 v[120:123], v8 offset:49152
  ds_read_b128 v[124:127], v8 offset:50176
  ds_read_b128 v[128:131], v9 offset:0
  ds_read_b128 v[132:135], v9 offset:1024
  ds_read_b128 v[136:139], v9 offset:16384
  ds_read_b128 v[140:143], v9 offset:17408
  ds_read_b128 v[144:147], v9 offset:32768
  ds_read_b128 v[148:151], v9 offset:33792
  ds_read_b128 v[152:155], v9 offset:49152
  ds_read_b128 v[156:159], v9 offset:50176
  s_waitcnt lgkmcnt(0)
  v_pk_add_f32 v[96:97], v[96:97], v[128:129]
  v_pk_add_f32 v[98:99], v[98:99], v[130:131]
  v_pk_add_f32 v[100:101], v[100:101], v[132:133]
  v_pk_add_f32 v[102:103], v[102:103], v[134:135]
  v_pk_add_f32 v[104:105], v[104:105], v[136:137]
  v_pk_add_f32 v[106:107], v[106:107], v[138:139]
  v_pk_add_f32 v[108:109], v[108:109], v[140:141]
  v_pk_add_f32 v[110:111], v[110:111], v[142:143]
  v_pk_add_f32 v[112:113], v[112:113], v[144:145]
  v_pk_add_f32 v[114:115], v[114:115], v[146:147]
  v_pk_add_f32 v[116:117], v[116:117], v[148:149]
  v_pk_add_f32 v[118:119], v[118:119], v[150:151]
  v_pk_add_f32 v[120:121], v[120:121], v[152:153]
  v_pk_add_f32 v[122:123], v[122:123], v[154:155]
  v_pk_add_f32 v[124:125], v[124:125], v[156:157]
  v_pk_add_f32 v[126:127], v[126:127], v[158:159]
  v_pk_add_f32 v[96:97], v[96:97], v[112:113]
  v_pk_add_f32 v[98:99], v[98:99], v[114:115]
  v_pk_add_f32 v[100:101], v[100:101], v[116:117]
  v_pk_add_f32 v[102:103], v[102:103], v[118:119]
  v_pk_add_f32 v[104:105], v[104:105], v[120:121]
  v_pk_add_f32 v[106:107], v[106:107], v[122:123]
  v_pk_add_f32 v[108:109], v[108:109], v[124:125]
  v_pk_add_f32 v[110:111], v[110:111], v[126:127]
  v_pk_add_f32 v[96:97], v[96:97], v[104:105]
  v_pk_add_f32 v[98:99], v[98:99], v[106:107]
  v_pk_add_f32 v[100:101], v[100:101], v[108:109]
  v_pk_add_f32 v[102:103], v[102:103], v[110:111]
  s_waitcnt vmcnt(0)
  v_cvt_pk_bf16_f32 v12, v96, v97
  v_lshlrev_b32 v96, 16, v12
  v_and_b32 v97, 0xffff0000, v12
  v_pk_mul_f32 v[96:97], v[96:97], v[80:81]
  v_cvt_pk_bf16_f32 v12, v96, v97
  v_lshlrev_b32 v96, 16, v12
  v_and_b32 v97, 0xffff0000, v12
  v_lshlrev_b32 v14, 16, v88
  v_and_b32 v15, 0xffff0000, v88
  v_pk_add_f32 v[96:97], v[96:97], v[14:15]
  v_cvt_pk_bf16_f32 v112, v96, v97
  v_cvt_pk_bf16_f32 v12, v98, v99
  v_lshlrev_b32 v98, 16, v12
  v_and_b32 v99, 0xffff0000, v12
  v_pk_mul_f32 v[98:99], v[98:99], v[82:83]
  v_cvt_pk_bf16_f32 v12, v98, v99
  v_lshlrev_b32 v98, 16, v12
  v_and_b32 v99, 0xffff0000, v12
  v_lshlrev_b32 v14, 16, v89
  v_and_b32 v15, 0xffff0000, v89
  v_pk_add_f32 v[98:99], v[98:99], v[14:15]
  v_cvt_pk_bf16_f32 v113, v98, v99
  buffer_store_dwordx2 v[112:113], v10, s[16:19], 0 offen offset:0
  v_cvt_pk_bf16_f32 v12, v100, v101
  v_lshlrev_b32 v100, 16, v12
  v_and_b32 v101, 0xffff0000, v12
  v_pk_mul_f32 v[100:101], v[100:101], v[84:85]
  v_cvt_pk_bf16_f32 v12, v100, v101
  v_lshlrev_b32 v100, 16, v12
  v_and_b32 v101, 0xffff0000, v12
  v_lshlrev_b32 v14, 16, v90
  v_and_b32 v15, 0xffff0000, v90
  v_pk_add_f32 v[100:101], v[100:101], v[14:15]
  v_cvt_pk_bf16_f32 v114, v100, v101
  v_cvt_pk_bf16_f32 v12, v102, v103
  v_lshlrev_b32 v102, 16, v12
  v_and_b32 v103, 0xffff0000, v12
  v_pk_mul_f32 v[102:103], v[102:103], v[86:87]
  v_cvt_pk_bf16_f32 v12, v102, v103
  v_lshlrev_b32 v102, 16, v12
  v_and_b32 v103, 0xffff0000, v12
  v_lshlrev_b32 v14, 16, v91
  v_and_b32 v15, 0xffff0000, v91
  v_pk_add_f32 v[102:103], v[102:103], v[14:15]
  v_cvt_pk_bf16_f32 v115, v102, v103
  buffer_store_dwordx2 v[114:115], v10, s[16:19], 0 offen offset:32
k_done:
  s_endpgm
.section .rodata,"a"
.p2align 6
.amdhsa_kernel adaLN_cond__spectral_gfnet__dense_activation_silu__prompt_kernel
  .amdhsa_next_free_vgpr 256
  .amdhsa_next_free_sgpr 102
  .amdhsa_accum_offset 256
  .amdhsa_group_segment_fixed_size 0
  .amdhsa_kernarg_size 88
  .amdhsa_user_sgpr_count 2
  .amdhsa_user_sgpr_kernarg_segment_ptr 1
  .amdhsa_system_sgpr_workgroup_id_x 1
.end_amdhsa_kernel
```
